```python
import torch

def _softmax(x, axis=-1):
    return torch.softmax(x, dim=axis)
def _gelu(x):
    return torch.nn.functional.gelu(x, approximate="tanh")
def _silu(x):
    return torch.nn.functional.silu(x)
def _sigmoid(x):
    return torch.sigmoid(x)
def _layernorm(x, axis=-1, eps=1e-5):
    m = x.mean(dim=axis, keepdim=True)
    v = x.var(dim=axis, keepdim=True, unbiased=False)
    return (x - m) / torch.sqrt(v + eps)
def _scatter_add(tgt, idx, src, axis=0):
    return tgt.clone().index_add_(axis, idx, src)
def _segment_sum(src, seg, n):
    out = torch.zeros((n,) + src.shape[1:], dtype=src.dtype)
    return out.index_add_(0, seg, src)
def _pad(x, pw):
    flat = tuple(v for pair in reversed(pw) for v in pair)
    return torch.nn.functional.pad(x, flat)

kernel_name = 'concat_heads__sliding_block_cached__gqa_block_cached__decode'

def setup_inputs():

    _w = (lambda a: (lambda t: t.to(torch.bfloat16) if t.is_floating_point() else t)(torch.as_tensor(a)))
    def _A_setup():
        B, Sq, D = 1, 1, 1024
        Hq, Hkv, Sk, Dh = 32, 4, 65536, 128
        assert Hq % Hkv == 0, (Hq, Hkv)
        return {
            "x": _w((lambda *s: torch.randn(*s, dtype=torch.bfloat16) * 0.2)(B, Sq, D)),
            "k_cache": _w((lambda *s: torch.randn(*s, dtype=torch.bfloat16) * 3.2)(B, Hkv, Sk, Dh)),
            "v_cache": _w((lambda *s: torch.randn(*s, dtype=torch.bfloat16) * 1.6)(B, Hkv, Sk, Dh)),
            "wq": _w((lambda *s: torch.randn(*s, dtype=torch.bfloat16) * 3.2)(D, Hq * Dh) * (D ** -0.5)),
            "wo": _w((lambda *s: torch.randn(*s, dtype=torch.bfloat16) * 1.6)(Hq * Dh, D) * ((Hq * Dh) ** -0.5)),
        }
    _A_in = _A_setup()

    def _B_setup():
        B, Sq, D = 1, 1, 1024
        Hq, Hkv, Sk, Dh = 32, 4, 65536, 128
        assert Hq % Hkv == 0, (Hq, Hkv)
        return {
            "x": _w((lambda *s: torch.randn(*s, dtype=torch.bfloat16) * 0.4)(B, Sq, D)),
            "k_cache": _w((lambda *s: torch.randn(*s, dtype=torch.bfloat16) * 3.2)(B, Hkv, Sk, Dh)),
            "v_cache": _w((lambda *s: torch.randn(*s, dtype=torch.bfloat16) * 0.8)(B, Hkv, Sk, Dh)),
            "wq": _w((lambda *s: torch.randn(*s, dtype=torch.bfloat16) * 3.2)(D, Hq * Dh) * (D ** -0.5)),
            "wo": _w((lambda *s: torch.randn(*s, dtype=torch.bfloat16) * 0.8)(Hq * Dh, D) * ((Hq * Dh) ** -0.5)),
        }
    _B_in = _B_setup()

    return {
        "A_x": _A_in["x"],
        "A_k_cache": _A_in["k_cache"],
        "A_v_cache": _A_in["v_cache"],
        "A_wq": _A_in["wq"],
        "A_wo": _A_in["wo"],
        "B_x": _B_in["x"],
        "B_k_cache": _B_in["k_cache"],
        "B_v_cache": _B_in["v_cache"],
        "B_wq": _B_in["wq"],
        "B_wo": _B_in["wo"],
    }

def reference(A_x, A_k_cache, A_v_cache, A_wq, A_wo, B_x, B_k_cache, B_v_cache, B_wq, B_wo):
    def _A_ref(x, k_cache, v_cache, wq, wo):
        B, Sq, D = x.shape
        Hq, Dh = 32, 128
        Hkv, Sk = k_cache.shape[1], k_cache.shape[2]
        W = min(4096, max(256, Sk // 4))
        rep = Hq // Hkv
        q = (lambda x, *d: x.permute(*d))((x @ wq).reshape(B, Sq, Hq, Dh), 0, 2, 1, 3)
        k = (lambda x, n, axis: torch.repeat_interleave(x, n, dim=axis))(k_cache[:, :, Sk - W:, :], rep, axis=1)
        v = (lambda x, n, axis: torch.repeat_interleave(x, n, dim=axis))(v_cache[:, :, Sk - W:, :], rep, axis=1)
        scores = torch.einsum("bhqd,bhkd->bhqk", q, k) * (Dh ** -0.5)
        p = _softmax(scores, axis=-1)
        o = torch.einsum("bhqk,bhkd->bhqd", p, v)
        return (lambda x, *d: x.permute(*d))(o, 0, 2, 1, 3).reshape(B, Sq, Hq * Dh) @ wo

    def _B_ref(x, k_cache, v_cache, wq, wo):
        B, Sq, D = x.shape
        Hq, Dh = 32, 128
        Hkv = k_cache.shape[1]
        rep = Hq // Hkv
        q = (lambda x, *d: x.permute(*d))((x @ wq).reshape(B, Sq, Hq, Dh), 0, 2, 1, 3)
        k = (lambda x, n, axis: torch.repeat_interleave(x, n, dim=axis))(k_cache, rep, axis=1)
        v = (lambda x, n, axis: torch.repeat_interleave(x, n, dim=axis))(v_cache, rep, axis=1)
        scores = torch.einsum("bhqd,bhkd->bhqk", q, k) * (Dh ** -0.5)
        p = _softmax(scores, axis=-1)
        o = torch.einsum("bhqk,bhkd->bhqd", p, v)
        return (lambda x, *d: x.permute(*d))(o, 0, 2, 1, 3).reshape(B, Sq, Hq * Dh) @ wo

    a = _A_ref(A_x, A_k_cache, A_v_cache, A_wq, A_wo)
    b = _B_ref(B_x, B_k_cache, B_v_cache, B_wq, B_wo)
    return torch.concatenate([a, b], axis=-1)
```

```asm
; @launch grid=(256,1,1) block=(320,1,1) lds=157776
.amdgcn_target "amdgcn-amd-amdhsa--gfx950"
.text

.globl concat_heads__sliding_block_cached__gqa_block_cached__decode_kernel
.p2align 8
.type concat_heads__sliding_block_cached__gqa_block_cached__decode_kernel,@function
concat_heads__sliding_block_cached__gqa_block_cached__decode_kernel:

    s_cmp_ge_u32 s2, 256
    s_cbranch_scc1 L_end
    s_load_dwordx16 s[4:19], s[0:1], 0
    s_load_dwordx8 s[20:27], s[0:1], 64
    s_load_dwordx2 s[28:29], s[0:1], 96

    v_lshrrev_b32 v1, 6, v0
    v_and_b32 v0, 63, v0
    v_readfirstlane_b32 s3, v1
    s_lshr_b32 s30, s2, 6
    s_and_b32 s31, s2, 63
    s_bfe_u32 s32, s2, 0x10003
    s_lshr_b32 s33, s2, 4
    s_lshl_b32 s33, s33, 3
    s_and_b32 s70, s2, 7
    s_add_u32 s33, s33, s70
    v_lshlrev_b32 v2, 4, v0
    v_lshrrev_b32 v8, 4, v0
    v_and_b32 v9, 15, v0
s_cmp_eq_u32 s3, 4
s_cbranch_scc1 L_sync

    v_lshrrev_b32 v72, 3, v0
    v_lshlrev_b32 v72, 16, v72
    v_and_b32 v15, 7, v0
    v_lshl_add_u32 v72, v15, 4, v72
    v_and_b32 v15, 1, v0
    v_lshl_add_u32 v4, v8, 1, v15
    v_lshlrev_b32 v4, 4, v4
s_and_b32 s78, s33, 63
s_lshl_b32 s78, s78, 7
s_lshr_b32 s70, s33, 6
s_lshl_b32 s70, s70, 22
s_add_u32 s78, s78, s70
s_lshl_b32 s70, s3, 20
s_add_u32 s78, s78, s70
s_lshr_b32 s80, s33, 6
s_lshl_b32 s80, s80, 10
s_lshl_b32 s70, s3, 8
s_add_u32 s80, s80, s70

    s_sub_u32 s54, 0x800000, s78
    s_mov_b32 s55, 0x20000
    s_mov_b32 s62, 2048
    s_mov_b32 s63, 0x20000
    s_cmp_eq_u32 s32, 0
    s_waitcnt lgkmcnt(0)
    s_cselect_b32 s52, s10, s20
    s_cselect_b32 s53, s11, s21
    s_cselect_b32 s60, s4, s14
    s_cselect_b32 s61, s5, s15
    s_cselect_b32 s56, s12, s22
    s_cselect_b32 s57, s13, s23
    s_add_u32 s52, s52, s78
    s_addc_u32 s53, s53, 0
buffer_load_dwordx4 v[80:83], v72, s[52:55], 0 offen nt
buffer_load_dwordx4 v[64:67], v4, s[60:63], s80 offen
buffer_load_dwordx4 v[68:71], v4, s[60:63], s80 offen offset:128
s_mov_b32 s70, 8192
buffer_load_dwordx4 v[84:87], v72, s[52:55], s70 offen nt
s_mov_b32 s70, 16384
buffer_load_dwordx4 v[88:91], v72, s[52:55], s70 offen nt
s_mov_b32 s70, 24576
buffer_load_dwordx4 v[92:95], v72, s[52:55], s70 offen nt
s_mov_b32 s70, 32768
buffer_load_dwordx4 v[96:99], v72, s[52:55], s70 offen nt
s_mov_b32 s70, 40960
buffer_load_dwordx4 v[100:103], v72, s[52:55], s70 offen nt
s_mov_b32 s70, 49152
buffer_load_dwordx4 v[104:107], v72, s[52:55], s70 offen nt
s_mov_b32 s70, 57344
buffer_load_dwordx4 v[108:111], v72, s[52:55], s70 offen nt
s_mov_b32 s70, 524288
buffer_load_dwordx4 v[112:115], v72, s[52:55], s70 offen nt

    s_load_dword s72, s[28:29], 0
    s_mov_b32 s73, 0x05040100
    s_mov_b32 s74, 0x07060302
    s_mov_b32 s75, 0x3db504f3
    s_mov_b32 s76, 0x3fb8aa3b
    s_mov_b32 s77, 0xffff0000
    s_lshl_b32 s78, s30, 24
s_lshl_b32 s80, s30, 24
s_lshl_b32 s70, s31, 14
s_add_u32 s80, s80, s70
s_lshl_b32 s70, s3, 12
s_add_u32 s80, s80, s70
s_add_u32 s80, s80, 15728640
s_add_u32 s36, s16, s78
s_addc_u32 s37, s17, 0
s_mov_b32 s38, 16777216
s_mov_b32 s39, 0x20000
s_add_u32 s40, s18, s78
s_addc_u32 s41, s19, 0
s_mov_b32 s42, 16777216
s_mov_b32 s43, 0x20000
s_add_u32 s44, s6, s80
s_addc_u32 s45, s7, 0
s_mov_b32 s46, 4096
s_mov_b32 s47, 0x20000
s_add_u32 s48, s8, s80
s_addc_u32 s49, s9, 0
s_mov_b32 s50, 4096
s_mov_b32 s51, 0x20000
s_mov_b32 s64, s28
s_mov_b32 s65, s29
s_mov_b32 s66, 3932160
s_mov_b32 s67, 0x20000
s_lshl_b32 s78, s33, 16
s_lshl_b32 s70, s3, 14
s_add_u32 s78, s78, s70
s_add_u32 s56, s56, s78
s_addc_u32 s57, s57, 0
s_mov_b32 s58, 0x4000
s_mov_b32 s59, 0x20000
s_lshl_b32 s71, s3, 13
s_lshl_b32 s70, s30, 22
s_add_u32 s71, s71, s70

    s_lshl_b32 s82, s31, 15
    s_add_u32 s82, s82, s71
    s_and_b32 s82, s82, 0xffffff
    s_mov_b32 s61, 4
    s_lshl_b32 s62, s3, 14
    s_mul_i32 s63, s3, 2080
    s_add_u32 s63, s63, 65536
    s_mul_i32 s69, s3, 4352
    s_add_u32 s69, s69, 132608
s_lshl_b32 s78, s30, 10
s_lshl_b32 s70, s3, 8
s_add_u32 s78, s78, s70
s_add_u32 s78, s78, 81920
s_add_u32 s34, s28, s78
s_addc_u32 s35, s29, 0
s_lshl_b32 s78, s32, 16
s_and_b32 s70, s33, 24
s_lshl_b32 s70, s70, 11
s_add_u32 s78, s78, s70
s_lshl_b32 s70, s3, 9
s_add_u32 s78, s78, s70
s_add_u32 s78, s78, 3538944
s_add_u32 s4, s28, s78
s_addc_u32 s5, s29, 0
s_lshl_b32 s12, s2, 12
s_add_u32 s12, s12, 262144
s_lshl_b32 s13, s30, 13
s_lshl_b32 s70, s3, 11
s_add_u32 s13, s13, s70
s_lshr_b32 s70, s31, 3
s_lshl_b32 s70, s70, 7
s_add_u32 s13, s13, s70
s_and_b32 s70, s31, 7
s_lshl_b32 s70, s70, 2
s_add_u32 s13, s13, s70
s_add_u32 s13, s13, 3670016
s_lshl_b32 s14, s30, 13
s_lshl_b32 s70, s3, 11
s_add_u32 s14, s14, s70
s_lshr_b32 s70, s31, 4
s_lshl_b32 s70, s70, 7
s_add_u32 s14, s14, s70
s_and_b32 s70, s31, 15
s_add_u32 s14, s14, s70
s_add_u32 s14, s14, 3473408
s_lshl_b32 s15, s32, 19
s_lshl_b32 s70, s33, 12
s_add_u32 s15, s15, s70
s_lshl_b32 s70, s3, 10
s_add_u32 s15, s15, s70
s_add_u32 s15, s15, 2359296
s_lshl_b32 s16, s32, 16
s_lshl_b32 s70, s3, 14
s_add_u32 s16, s16, s70
s_lshr_b32 s70, s33, 3
s_lshl_b32 s70, s70, 7
s_add_u32 s16, s16, s70
s_and_b32 s70, s33, 7
s_add_u32 s16, s16, s70
s_add_u32 s16, s16, 3538944
s_lshl_b32 s17, s32, 19
s_lshl_b32 s70, s3, 17
s_add_u32 s17, s17, s70
s_lshl_b32 s70, s33, 7
s_add_u32 s17, s17, s70
s_add_u32 s17, s17, 2359296
s_lshl_b32 s18, s32, 11
s_lshl_b32 s70, s33, 6
s_add_u32 s18, s18, s70

    s_movk_i32 s19, 0xff
    s_movk_i32 s20, 0xff00
    v_lshlrev_b32 v15, 2, v8
    v_xor_b32 v15, v15, v9
    v_lshlrev_b32 v15, 4, v15
    v_lshl_add_u32 v160, v8, 8, v15
    v_xor_b32 v161, 16, v160
    v_xor_b32 v162, 32, v160
    v_xor_b32 v163, 48, v160
    v_and_b32 v15, 3, v9
    v_lshrrev_b32 v1, 2, v9
    v_lshl_add_u32 v1, v15, 2, v1
    v_lshlrev_b32 v1, 8, v1
    v_xor_b32 v15, v8, v9
    v_lshl_add_u32 v1, v15, 4, v1
    v_add_u32 v164, s62, v1
    v_xor_b32 v165, 64, v164
    v_xor_b32 v166, 128, v164
    v_xor_b32 v167, 192, v164
    v_and_b32 v15, 7, v9
    v_mul_u32_u24 v10, 272, v15
    v_lshl_add_u32 v10, v8, 4, v10
    v_add_u32 v10, 152064, v10
    v_mul_u32_u24 v11, 528, v15
    v_lshl_add_u32 v11, v8, 7, v11
    v_add_u32 v168, s62, v11
    v_add_u32 v11, s69, v11
    v_lshrrev_b32 v15, 5, v0
    s_lshl_b32 s78, s3, 1
    v_add_u32 v15, s78, v15
    v_mul_u32_u24 v12, 528, v15
    v_and_b32 v7, 31, v0
    v_lshl_add_u32 v12, v7, 4, v12
    v_lshlrev_b32 v13, 9, v15
    v_lshl_add_u32 v13, v7, 4, v13
    v_lshlrev_b32 v3, 5, v15
    v_add_u32 v3, 156416, v3
    v_lshlrev_b32 v169, 5, v0
    s_lshl_b32 s78, s3, 3
    s_add_u32 s78, s78, 156416
    v_add_u32 v4, s78, v169
    v_mul_u32_u24 v170, 16768, v8
    v_bfe_u32 v15, v0, 2, 2
    v_mul_u32_u24 v15, 2080, v15
    v_add_u32 v170, v170, v15
    v_and_b32 v15, 3, v0
    v_lshl_add_u32 v170, v15, 3, v170
    s_lshl_b32 s78, s3, 9
    s_add_u32 s78, s78, 65536
    v_add_u32 v170, s78, v170
    v_lshlrev_b32 v172, 6, v9
    v_lshl_add_u32 v172, v8, 4, v172
    v_lshlrev_b32 v171, 4, v8
    v_add_u32 v171, 157696, v171
    v_lshrrev_b32 v173, 3, v0
    v_lshlrev_b32 v173, 12, v173
    v_and_b32 v15, 7, v0
    v_lshl_add_u32 v173, v15, 4, v173
    v_lshlrev_b32 v174, 11, v0
    s_lshl_b32 s78, s3, 7
    s_add_u32 s78, s78, 157184
    v_add_u32 v175, s78, v2
    v_mov_b32 v14, 157760
s_mov_b32 s70, 532480
buffer_load_dwordx4 v[116:119], v72, s[52:55], s70 offen nt
s_mov_b32 s70, 540672
buffer_load_dwordx4 v[120:123], v72, s[52:55], s70 offen nt
s_mov_b32 s70, 548864
buffer_load_dwordx4 v[124:127], v72, s[52:55], s70 offen nt
s_mov_b32 s70, 557056
buffer_load_dwordx4 v[128:131], v72, s[52:55], s70 offen nt
s_mov_b32 s70, 565248
buffer_load_dwordx4 v[132:135], v72, s[52:55], s70 offen nt
s_mov_b32 s70, 573440
buffer_load_dwordx4 v[136:139], v72, s[52:55], s70 offen nt
s_mov_b32 s70, 581632
buffer_load_dwordx4 v[140:143], v72, s[52:55], s70 offen nt
s_waitcnt vmcnt(8)
v_perm_b32 v48, v84, v80, s73
v_perm_b32 v49, v92, v88, s73
v_perm_b32 v50, v100, v96, s73
v_perm_b32 v51, v108, v104, s73
v_perm_b32 v52, v84, v80, s74
v_perm_b32 v53, v92, v88, s74
v_perm_b32 v54, v100, v96, s74
v_perm_b32 v55, v108, v104, s74
v_mfma_f32_16x16x32_bf16 a[0:3], v[48:51], v[64:67], 0
v_perm_b32 v56, v85, v81, s73
v_perm_b32 v57, v93, v89, s73
v_perm_b32 v58, v101, v97, s73
v_perm_b32 v59, v109, v105, s73
v_mfma_f32_16x16x32_bf16 a[4:7], v[52:55], v[64:67], 0
v_perm_b32 v60, v85, v81, s74
v_perm_b32 v61, v93, v89, s74
v_perm_b32 v62, v101, v97, s74
v_perm_b32 v63, v109, v105, s74
v_mfma_f32_16x16x32_bf16 a[8:11], v[56:59], v[64:67], 0
v_perm_b32 v48, v86, v82, s73
v_perm_b32 v49, v94, v90, s73
v_perm_b32 v50, v102, v98, s73
v_perm_b32 v51, v110, v106, s73
v_mfma_f32_16x16x32_bf16 a[12:15], v[60:63], v[64:67], 0
v_perm_b32 v52, v86, v82, s74
v_perm_b32 v53, v94, v90, s74
v_perm_b32 v54, v102, v98, s74
v_perm_b32 v55, v110, v106, s74
v_mfma_f32_16x16x32_bf16 a[16:19], v[48:51], v[64:67], 0
v_perm_b32 v56, v87, v83, s73
v_perm_b32 v57, v95, v91, s73
v_perm_b32 v58, v103, v99, s73
v_perm_b32 v59, v111, v107, s73
v_mfma_f32_16x16x32_bf16 a[20:23], v[52:55], v[64:67], 0
v_perm_b32 v60, v87, v83, s74
v_perm_b32 v61, v95, v91, s74
v_perm_b32 v62, v103, v99, s74
v_perm_b32 v63, v111, v107, s74
v_mfma_f32_16x16x32_bf16 a[24:27], v[56:59], v[64:67], 0
s_nop 1
v_mfma_f32_16x16x32_bf16 a[28:31], v[60:63], v[64:67], 0
s_add_u32 m0, s69, 0
s_waitcnt vmcnt(7)
buffer_load_dwordx4 v160, s[44:47], 0 offen offset:0 nt lds
s_waitcnt vmcnt(7)
buffer_load_dwordx4 v161, s[44:47], 0 offen offset:1024 nt lds
s_waitcnt vmcnt(7)
buffer_load_dwordx4 v162, s[44:47], 0 offen offset:2048 nt lds
s_waitcnt vmcnt(7)
buffer_load_dwordx4 v163, s[44:47], 0 offen offset:3072 nt lds
s_waitcnt vmcnt(7)
buffer_load_dwordx4 v[144:147], v2, s[48:51], 0 offen offset:0 nt
s_waitcnt vmcnt(7)
buffer_load_dwordx4 v[148:151], v2, s[48:51], 0 offen offset:1024 nt
s_waitcnt vmcnt(7)
buffer_load_dwordx4 v[152:155], v2, s[48:51], 0 offen offset:2048 nt
s_waitcnt vmcnt(7)
buffer_load_dwordx4 v[156:159], v2, s[48:51], 0 offen offset:3072 nt
s_waitcnt vmcnt(8)
v_perm_b32 v48, v116, v112, s73
v_perm_b32 v49, v124, v120, s73
v_perm_b32 v50, v132, v128, s73
v_perm_b32 v51, v140, v136, s73
v_perm_b32 v52, v116, v112, s74
v_perm_b32 v53, v124, v120, s74
v_perm_b32 v54, v132, v128, s74
v_perm_b32 v55, v140, v136, s74
v_mfma_f32_16x16x32_bf16 a[0:3], v[48:51], v[68:71], a[0:3]
v_perm_b32 v56, v117, v113, s73
v_perm_b32 v57, v125, v121, s73
v_perm_b32 v58, v133, v129, s73
v_perm_b32 v59, v141, v137, s73
v_mfma_f32_16x16x32_bf16 a[4:7], v[52:55], v[68:71], a[4:7]
v_perm_b32 v60, v117, v113, s74
v_perm_b32 v61, v125, v121, s74
v_perm_b32 v62, v133, v129, s74
v_perm_b32 v63, v141, v137, s74
v_mfma_f32_16x16x32_bf16 a[8:11], v[56:59], v[68:71], a[8:11]
v_perm_b32 v48, v118, v114, s73
v_perm_b32 v49, v126, v122, s73
v_perm_b32 v50, v134, v130, s73
v_perm_b32 v51, v142, v138, s73
v_mfma_f32_16x16x32_bf16 a[12:15], v[60:63], v[68:71], a[12:15]
v_perm_b32 v52, v118, v114, s74
v_perm_b32 v53, v126, v122, s74
v_perm_b32 v54, v134, v130, s74
v_perm_b32 v55, v142, v138, s74
v_mfma_f32_16x16x32_bf16 a[16:19], v[48:51], v[68:71], a[16:19]
v_perm_b32 v56, v119, v115, s73
v_perm_b32 v57, v127, v123, s73
v_perm_b32 v58, v135, v131, s73
v_perm_b32 v59, v143, v139, s73
v_mfma_f32_16x16x32_bf16 a[20:23], v[52:55], v[68:71], a[20:23]
v_perm_b32 v60, v119, v115, s74
v_perm_b32 v61, v127, v123, s74
v_perm_b32 v62, v135, v131, s74
v_perm_b32 v63, v143, v139, s74
v_mfma_f32_16x16x32_bf16 a[24:27], v[56:59], v[68:71], a[24:27]
s_nop 1
v_mfma_f32_16x16x32_bf16 a[28:31], v[60:63], v[68:71], a[28:31]

    v_lshlrev_b32 v15, 7, v8
    s_lshl_b32 s78, s3, 9
    s_add_u32 s78, s78, 150016
    v_add_u32 v15, s78, v15
    s_mov_b32 exec_lo, 0x00010001
    s_mov_b32 exec_hi, 0x00020002
    s_nop 3
ds_write_b128 v15, a[0:3] offset:0
ds_write_b128 v15, a[4:7] offset:16
ds_write_b128 v15, a[8:11] offset:32
ds_write_b128 v15, a[12:15] offset:48
ds_write_b128 v15, a[16:19] offset:64
ds_write_b128 v15, a[20:23] offset:80
ds_write_b128 v15, a[24:27] offset:96
ds_write_b128 v15, a[28:31] offset:112
s_mov_b64 exec, -1
    s_waitcnt lgkmcnt(0)
    s_barrier
    s_add_u32 s72, s72, 1
    s_and_b32 s83, s72, 0xff
    s_mul_i32 s22, s83, 0x01010101
    s_mov_b32 s23, s22
    v_mov_b32 v1, s83
s_add_u32 m0, s62, 0
s_waitcnt vmcnt(7)
buffer_load_dwordx4 v160, s[36:39], s82 offen offset:0 nt lds
s_waitcnt vmcnt(7)
buffer_load_dwordx4 v161, s[36:39], s82 offen offset:1024 nt lds
s_waitcnt vmcnt(7)
buffer_load_dwordx4 v162, s[36:39], s82 offen offset:2048 nt lds
s_waitcnt vmcnt(7)
buffer_load_dwordx4 v163, s[36:39], s82 offen offset:3072 nt lds
s_add_u32 m0, s62, 4096
s_add_u32 s70, s82, 4096
s_waitcnt vmcnt(7)
buffer_load_dwordx4 v160, s[36:39], s70 offen offset:0 nt lds
s_waitcnt vmcnt(7)
buffer_load_dwordx4 v161, s[36:39], s70 offen offset:1024 nt lds
s_waitcnt vmcnt(7)
buffer_load_dwordx4 v162, s[36:39], s70 offen offset:2048 nt lds
s_waitcnt vmcnt(7)
buffer_load_dwordx4 v163, s[36:39], s70 offen offset:3072 nt lds
s_waitcnt vmcnt(7)
buffer_load_dwordx4 v[16:19], v2, s[40:43], s82 offen offset:0 nt
s_waitcnt vmcnt(7)
buffer_load_dwordx4 v[20:23], v2, s[40:43], s82 offen offset:1024 nt
s_waitcnt vmcnt(7)
buffer_load_dwordx4 v[24:27], v2, s[40:43], s82 offen offset:2048 nt
s_waitcnt vmcnt(7)
buffer_load_dwordx4 v[28:31], v2, s[40:43], s82 offen offset:3072 nt
s_add_u32 s70, s82, 4096
s_waitcnt vmcnt(7)
buffer_load_dwordx4 v[32:35], v2, s[40:43], s70 offen offset:0 nt
s_waitcnt vmcnt(7)
buffer_load_dwordx4 v[36:39], v2, s[40:43], s70 offen offset:1024 nt
s_waitcnt vmcnt(7)
buffer_load_dwordx4 v[40:43], v2, s[40:43], s70 offen offset:2048 nt
s_waitcnt vmcnt(7)
buffer_load_dwordx4 v[44:47], v2, s[40:43], s70 offen offset:3072 nt
s_add_u32 s82, s82, 0x200000
s_and_b32 s82, s82, 0xffffff
s_add_u32 m0, s62, 8192
s_waitcnt vmcnt(7)
buffer_load_dwordx4 v160, s[36:39], s82 offen offset:0 nt lds
s_waitcnt vmcnt(7)
buffer_load_dwordx4 v161, s[36:39], s82 offen offset:1024 nt lds
s_barrier
s_waitcnt vmcnt(7)
buffer_load_dwordx4 v162, s[36:39], s82 offen offset:2048 nt lds
s_waitcnt vmcnt(7)
buffer_load_dwordx4 v163, s[36:39], s82 offen offset:3072 nt lds
s_add_u32 m0, s62, 12288
s_add_u32 s70, s82, 4096
s_waitcnt vmcnt(7)
buffer_load_dwordx4 v160, s[36:39], s70 offen offset:0 nt lds
s_waitcnt vmcnt(7)
buffer_load_dwordx4 v161, s[36:39], s70 offen offset:1024 nt lds
s_waitcnt vmcnt(7)
buffer_load_dwordx4 v162, s[36:39], s70 offen offset:2048 nt lds
s_waitcnt vmcnt(7)
buffer_load_dwordx4 v163, s[36:39], s70 offen offset:3072 nt lds
s_waitcnt vmcnt(7)
buffer_load_dwordx4 v[48:51], v2, s[40:43], s82 offen offset:0 nt
s_waitcnt vmcnt(7)
buffer_load_dwordx4 v[52:55], v2, s[40:43], s82 offen offset:1024 nt
s_waitcnt vmcnt(7)
buffer_load_dwordx4 v[56:59], v2, s[40:43], s82 offen offset:2048 nt
s_waitcnt vmcnt(7)
buffer_load_dwordx4 v[60:63], v2, s[40:43], s82 offen offset:3072 nt
s_add_u32 s70, s82, 4096
s_waitcnt vmcnt(7)
buffer_load_dwordx4 v[64:67], v2, s[40:43], s70 offen offset:0 nt
s_waitcnt vmcnt(7)
buffer_load_dwordx4 v[68:71], v2, s[40:43], s70 offen offset:1024 nt
s_waitcnt vmcnt(7)
buffer_load_dwordx4 v[72:75], v2, s[40:43], s70 offen offset:2048 nt
s_waitcnt vmcnt(7)
buffer_load_dwordx4 v[76:79], v2, s[40:43], s70 offen offset:3072 nt
s_barrier
ds_read_b128 a[64:67], v10 offset:2176
ds_read_b128 a[68:71], v10 offset:2240
ds_read_b128 a[72:75], v10 offset:2304
ds_read_b128 a[76:79], v10 offset:2368
v_mov_b64 v[80:81], 0
v_mov_b64 v[82:83], 0
v_mov_b64 v[84:85], 0
v_mov_b64 v[86:87], 0
v_mov_b64 v[88:89], 0
v_mov_b64 v[90:91], 0
v_mov_b64 v[92:93], 0
v_mov_b64 v[94:95], 0
v_mov_b64 v[96:97], 0
v_mov_b64 v[98:99], 0
v_mov_b64 v[100:101], 0
v_mov_b64 v[102:103], 0
v_mov_b64 v[104:105], 0
v_mov_b64 v[106:107], 0
v_mov_b64 v[108:109], 0
v_mov_b64 v[110:111], 0
v_mov_b32 v5, 0xff7fffff
v_mov_b32 v6, 0
s_mov_b32 s81, 0
s_mov_b32 s68, 0
s_cmp_ge_u32 s33, 32
s_cbranch_scc1 L_nowarm
s_load_dword s6, s[4:5], 0 glc
s_load_dword s7, s[4:5], 128 glc
s_load_dword s8, s[4:5], 256 glc
s_load_dword s9, s[4:5], 384 glc
L_nowarm:
L_top0:
s_cmp_lt_u32 s81, 2
    s_waitcnt vmcnt(24)
    s_cbranch_scc1 L_w10
    s_cmp_eq_u32 s68, 0
    s_waitcnt vmcnt(8)
    s_cbranch_scc1 L_w10
    s_waitcnt vmcnt(4)
L_w10:
ds_read_b128 a[0:3], v164 offset:0
ds_read_b128 a[16:19], v164 offset:4096
ds_read_b128 a[4:7], v165 offset:0
ds_read_b128 a[20:23], v165 offset:4096
ds_read_b128 a[8:11], v166 offset:0
ds_read_b128 a[24:27], v166 offset:4096
ds_read_b128 a[12:15], v167 offset:0
ds_read_b128 a[28:31], v167 offset:4096
s_waitcnt lgkmcnt(7)
v_mfma_f32_16x16x32_bf16 v[128:131], a[0:3], a[64:67], 0
s_waitcnt lgkmcnt(6)
v_mfma_f32_16x16x32_bf16 v[132:135], a[16:19], a[64:67], 0
s_waitcnt lgkmcnt(5)
v_mfma_f32_16x16x32_bf16 v[128:131], a[4:7], a[68:71], v[128:131]
s_waitcnt lgkmcnt(4)
v_mfma_f32_16x16x32_bf16 v[132:135], a[20:23], a[68:71], v[132:135]
s_waitcnt lgkmcnt(3)
v_mfma_f32_16x16x32_bf16 v[128:131], a[8:11], a[72:75], v[128:131]
s_waitcnt lgkmcnt(2)
v_mfma_f32_16x16x32_bf16 v[132:135], a[24:27], a[72:75], v[132:135]
s_waitcnt lgkmcnt(1)
v_mfma_f32_16x16x32_bf16 v[128:131], a[12:15], a[76:79], v[128:131]
s_waitcnt lgkmcnt(0)
v_mfma_f32_16x16x32_bf16 v[132:135], a[28:31], a[76:79], v[132:135]
s_nop 7
v_cvt_pk_bf16_f32 v136, v128, v129
v_cvt_pk_bf16_f32 v137, v130, v131
v_cvt_pk_bf16_f32 v138, v132, v133
v_cvt_pk_bf16_f32 v139, v134, v135
v_lshlrev_b32 v128, 16, v136
v_and_b32 v129, s77, v136
v_lshlrev_b32 v130, 16, v137
v_and_b32 v131, s77, v137
v_lshlrev_b32 v132, 16, v138
v_and_b32 v133, s77, v138
v_lshlrev_b32 v134, 16, v139
v_and_b32 v135, s77, v139
v_mul_f32 v128, s75, v128
v_mul_f32 v129, s75, v129
v_mul_f32 v130, s75, v130
v_mul_f32 v131, s75, v131
v_mul_f32 v132, s75, v132
v_mul_f32 v133, s75, v133
v_mul_f32 v134, s75, v134
v_mul_f32 v135, s75, v135
v_cvt_pk_bf16_f32 v136, v128, v129
v_cvt_pk_bf16_f32 v137, v130, v131
v_cvt_pk_bf16_f32 v138, v132, v133
v_cvt_pk_bf16_f32 v139, v134, v135
v_lshlrev_b32 v128, 16, v136
v_and_b32 v129, s77, v136
v_lshlrev_b32 v130, 16, v137
v_and_b32 v131, s77, v137
v_lshlrev_b32 v132, 16, v138
v_and_b32 v133, s77, v138
v_lshlrev_b32 v134, 16, v139
v_and_b32 v135, s77, v139
s_cmp_eq_u32 s68, 0
s_cbranch_scc1 L_full0
v_mov_b32 v132, 0xff800000
v_mov_b32 v133, 0xff800000
v_mov_b32 v134, 0xff800000
v_mov_b32 v135, 0xff800000
L_full0:
v_max3_f32 v8, v128, v129, v5
v_max3_f32 v9, v130, v131, v132
v_max3_f32 v8, v8, v133, v134
v_max3_f32 v8, v8, v9, v135
v_mov_b32 v15, v8
s_nop 1
v_permlane16_swap_b32 v8, v15
s_nop 1
v_max_f32 v8, v8, v15
v_mov_b32 v15, v8
s_nop 1
v_permlane32_swap_b32 v8, v15
s_nop 1
v_max_f32 v8, v8, v15

    v_cmp_gt_f32 vcc, v8, v5
    s_cbranch_vccz L_nors0
    v_sub_f32 v9, v5, v8
    v_mul_f32 v9, s76, v9
    v_exp_f32 v9, v9
    v_mov_b32 v5, v8
    v_mul_f32 v6, v6, v9
v_mul_f32 v80, v80, v9
v_mul_f32 v81, v81, v9
v_mul_f32 v82, v82, v9
v_mul_f32 v83, v83, v9
v_mul_f32 v84, v84, v9
v_mul_f32 v85, v85, v9
v_mul_f32 v86, v86, v9
v_mul_f32 v87, v87, v9
v_mul_f32 v88, v88, v9
v_mul_f32 v89, v89, v9
v_mul_f32 v90, v90, v9
v_mul_f32 v91, v91, v9
v_mul_f32 v92, v92, v9
v_mul_f32 v93, v93, v9
v_mul_f32 v94, v94, v9
v_mul_f32 v95, v95, v9
v_mul_f32 v96, v96, v9
v_mul_f32 v97, v97, v9
v_mul_f32 v98, v98, v9
v_mul_f32 v99, v99, v9
v_mul_f32 v100, v100, v9
v_mul_f32 v101, v101, v9
v_mul_f32 v102, v102, v9
v_mul_f32 v103, v103, v9
v_mul_f32 v104, v104, v9
v_mul_f32 v105, v105, v9
v_mul_f32 v106, v106, v9
v_mul_f32 v107, v107, v9
v_mul_f32 v108, v108, v9
v_mul_f32 v109, v109, v9
v_mul_f32 v110, v110, v9
v_mul_f32 v111, v111, v9
L_nors0:
v_mul_f32 v7, s76, v5
v_fma_f32 v128, v128, s76, -v7
v_fma_f32 v129, v129, s76, -v7
v_fma_f32 v130, v130, s76, -v7
v_fma_f32 v131, v131, s76, -v7
v_fma_f32 v132, v132, s76, -v7
v_fma_f32 v133, v133, s76, -v7
v_fma_f32 v134, v134, s76, -v7
v_fma_f32 v135, v135, s76, -v7
v_exp_f32 v128, v128
v_exp_f32 v129, v129
v_exp_f32 v130, v130
v_exp_f32 v131, v131
v_exp_f32 v132, v132
v_exp_f32 v133, v133
v_exp_f32 v134, v134
v_exp_f32 v135, v135
s_nop 0
v_cvt_pk_bf16_f32 v140, v128, v129
v_cvt_pk_bf16_f32 v141, v130, v131
v_cvt_pk_bf16_f32 v142, v132, v133
v_cvt_pk_bf16_f32 v143, v134, v135
v_add_f32 v128, v128, v129
v_add_f32 v130, v130, v131
v_add_f32 v132, v132, v133
v_add_f32 v134, v134, v135
v_add_f32 v128, v128, v130
v_add_f32 v132, v132, v134
v_add_f32 v128, v128, v132
v_add_f32 v6, v6, v128

    s_cmp_lg_u32 s81, 0
    s_cbranch_scc1 L_s1d0
    s_sub_u32 s61, s61, 1
    s_cbranch_scc1 L_s1t0
    s_add_u32 s82, s82, 0x200000
    s_and_b32 s82, s82, 0xffffff
s_add_u32 m0, s62, 0
s_waitcnt vmcnt(15)
buffer_load_dwordx4 v160, s[36:39], s82 offen offset:0 nt lds
s_waitcnt vmcnt(15)
buffer_load_dwordx4 v161, s[36:39], s82 offen offset:1024 nt lds
s_waitcnt vmcnt(15)
buffer_load_dwordx4 v162, s[36:39], s82 offen offset:2048 nt lds
s_waitcnt vmcnt(15)
buffer_load_dwordx4 v163, s[36:39], s82 offen offset:3072 nt lds
s_add_u32 m0, s62, 4096
s_add_u32 s70, s82, 4096
s_waitcnt vmcnt(15)
buffer_load_dwordx4 v160, s[36:39], s70 offen offset:0 nt lds
s_waitcnt vmcnt(15)
buffer_load_dwordx4 v161, s[36:39], s70 offen offset:1024 nt lds
s_waitcnt vmcnt(15)
buffer_load_dwordx4 v162, s[36:39], s70 offen offset:2048 nt lds
s_waitcnt vmcnt(15)
buffer_load_dwordx4 v163, s[36:39], s70 offen offset:3072 nt lds
L_s1r0:
s_waitcnt vmcnt(16)
L_pv0:
v_perm_b32 v112, v20, v16, s73
v_perm_b32 v113, v28, v24, s73
v_perm_b32 v114, v36, v32, s73
v_perm_b32 v115, v44, v40, s73
v_perm_b32 v116, v20, v16, s74
v_perm_b32 v117, v28, v24, s74
v_perm_b32 v118, v36, v32, s74
v_perm_b32 v119, v44, v40, s74
v_mfma_f32_16x16x32_bf16 v[80:83], v[112:115], v[140:143], v[80:83]
v_perm_b32 v120, v21, v17, s73
v_perm_b32 v121, v29, v25, s73
v_perm_b32 v122, v37, v33, s73
v_perm_b32 v123, v45, v41, s73
v_mfma_f32_16x16x32_bf16 v[84:87], v[116:119], v[140:143], v[84:87]
v_perm_b32 v124, v21, v17, s74
v_perm_b32 v125, v29, v25, s74
v_perm_b32 v126, v37, v33, s74
v_perm_b32 v127, v45, v41, s74
v_mfma_f32_16x16x32_bf16 v[88:91], v[120:123], v[140:143], v[88:91]
v_perm_b32 v112, v22, v18, s73
v_perm_b32 v113, v30, v26, s73
v_perm_b32 v114, v38, v34, s73
v_perm_b32 v115, v46, v42, s73
v_mfma_f32_16x16x32_bf16 v[92:95], v[124:127], v[140:143], v[92:95]
v_perm_b32 v116, v22, v18, s74
v_perm_b32 v117, v30, v26, s74
v_perm_b32 v118, v38, v34, s74
v_perm_b32 v119, v46, v42, s74
v_mfma_f32_16x16x32_bf16 v[96:99], v[112:115], v[140:143], v[96:99]
v_perm_b32 v120, v23, v19, s73
v_perm_b32 v121, v31, v27, s73
v_perm_b32 v122, v39, v35, s73
v_perm_b32 v123, v47, v43, s73
v_mfma_f32_16x16x32_bf16 v[100:103], v[116:119], v[140:143], v[100:103]
v_perm_b32 v124, v23, v19, s74
v_perm_b32 v125, v31, v27, s74
v_perm_b32 v126, v39, v35, s74
v_perm_b32 v127, v47, v43, s74
v_mfma_f32_16x16x32_bf16 v[104:107], v[120:123], v[140:143], v[104:107]
s_nop 1
v_mfma_f32_16x16x32_bf16 v[108:111], v[124:127], v[140:143], v[108:111]
s_cmp_lg_u32 s81, 0
s_cbranch_scc1 L_s2d0
s_waitcnt vmcnt(15)
buffer_load_dwordx4 v[16:19], v2, s[40:43], s82 offen offset:0 nt
s_waitcnt vmcnt(15)
buffer_load_dwordx4 v[20:23], v2, s[40:43], s82 offen offset:1024 nt
s_waitcnt vmcnt(15)
buffer_load_dwordx4 v[24:27], v2, s[40:43], s82 offen offset:2048 nt
s_waitcnt vmcnt(15)
buffer_load_dwordx4 v[28:31], v2, s[40:43], s82 offen offset:3072 nt
s_add_u32 s70, s82, 4096
s_waitcnt vmcnt(15)
buffer_load_dwordx4 v[32:35], v2, s[40:43], s70 offen offset:0 nt
s_waitcnt vmcnt(15)
buffer_load_dwordx4 v[36:39], v2, s[40:43], s70 offen offset:1024 nt
s_waitcnt vmcnt(15)
buffer_load_dwordx4 v[40:43], v2, s[40:43], s70 offen offset:2048 nt
s_waitcnt vmcnt(15)
buffer_load_dwordx4 v[44:47], v2, s[40:43], s70 offen offset:3072 nt
L_top1:
s_cmp_lt_u32 s81, 2
    s_waitcnt vmcnt(24)
    s_cbranch_scc1 L_w11
    s_cmp_eq_u32 s68, 0
    s_waitcnt vmcnt(8)
    s_cbranch_scc1 L_w11
    s_waitcnt vmcnt(4)
L_w11:
ds_read_b128 a[0:3], v164 offset:8192
ds_read_b128 a[16:19], v164 offset:12288
ds_read_b128 a[4:7], v165 offset:8192
ds_read_b128 a[20:23], v165 offset:12288
ds_read_b128 a[8:11], v166 offset:8192
ds_read_b128 a[24:27], v166 offset:12288
ds_read_b128 a[12:15], v167 offset:8192
ds_read_b128 a[28:31], v167 offset:12288
s_waitcnt lgkmcnt(7)
v_mfma_f32_16x16x32_bf16 v[128:131], a[0:3], a[64:67], 0
s_waitcnt lgkmcnt(6)
v_mfma_f32_16x16x32_bf16 v[132:135], a[16:19], a[64:67], 0
s_waitcnt lgkmcnt(5)
v_mfma_f32_16x16x32_bf16 v[128:131], a[4:7], a[68:71], v[128:131]
s_waitcnt lgkmcnt(4)
v_mfma_f32_16x16x32_bf16 v[132:135], a[20:23], a[68:71], v[132:135]
s_waitcnt lgkmcnt(3)
v_mfma_f32_16x16x32_bf16 v[128:131], a[8:11], a[72:75], v[128:131]
s_waitcnt lgkmcnt(2)
v_mfma_f32_16x16x32_bf16 v[132:135], a[24:27], a[72:75], v[132:135]
s_waitcnt lgkmcnt(1)
v_mfma_f32_16x16x32_bf16 v[128:131], a[12:15], a[76:79], v[128:131]
s_waitcnt lgkmcnt(0)
v_mfma_f32_16x16x32_bf16 v[132:135], a[28:31], a[76:79], v[132:135]
s_nop 7
v_cvt_pk_bf16_f32 v136, v128, v129
v_cvt_pk_bf16_f32 v137, v130, v131
v_cvt_pk_bf16_f32 v138, v132, v133
v_cvt_pk_bf16_f32 v139, v134, v135
v_lshlrev_b32 v128, 16, v136
v_and_b32 v129, s77, v136
v_lshlrev_b32 v130, 16, v137
v_and_b32 v131, s77, v137
v_lshlrev_b32 v132, 16, v138
v_and_b32 v133, s77, v138
v_lshlrev_b32 v134, 16, v139
v_and_b32 v135, s77, v139
v_mul_f32 v128, s75, v128
v_mul_f32 v129, s75, v129
v_mul_f32 v130, s75, v130
v_mul_f32 v131, s75, v131
v_mul_f32 v132, s75, v132
v_mul_f32 v133, s75, v133
v_mul_f32 v134, s75, v134
v_mul_f32 v135, s75, v135
v_cvt_pk_bf16_f32 v136, v128, v129
v_cvt_pk_bf16_f32 v137, v130, v131
v_cvt_pk_bf16_f32 v138, v132, v133
v_cvt_pk_bf16_f32 v139, v134, v135
v_lshlrev_b32 v128, 16, v136
v_and_b32 v129, s77, v136
v_lshlrev_b32 v130, 16, v137
v_and_b32 v131, s77, v137
v_lshlrev_b32 v132, 16, v138
v_and_b32 v133, s77, v138
v_lshlrev_b32 v134, 16, v139
v_and_b32 v135, s77, v139
s_cmp_eq_u32 s68, 0
s_cbranch_scc1 L_full1
v_mov_b32 v132, 0xff800000
v_mov_b32 v133, 0xff800000
v_mov_b32 v134, 0xff800000
v_mov_b32 v135, 0xff800000
L_full1:
v_max3_f32 v8, v128, v129, v5
v_max3_f32 v9, v130, v131, v132
v_max3_f32 v8, v8, v133, v134
v_max3_f32 v8, v8, v9, v135
v_mov_b32 v15, v8
s_nop 1
v_permlane16_swap_b32 v8, v15
s_nop 1
v_max_f32 v8, v8, v15
v_mov_b32 v15, v8
s_nop 1
v_permlane32_swap_b32 v8, v15
s_nop 1
v_max_f32 v8, v8, v15

    v_cmp_gt_f32 vcc, v8, v5
    s_cbranch_vccz L_nors1
    v_sub_f32 v9, v5, v8
    v_mul_f32 v9, s76, v9
    v_exp_f32 v9, v9
    v_mov_b32 v5, v8
    v_mul_f32 v6, v6, v9
v_mul_f32 v80, v80, v9
v_mul_f32 v81, v81, v9
v_mul_f32 v82, v82, v9
v_mul_f32 v83, v83, v9
v_mul_f32 v84, v84, v9
v_mul_f32 v85, v85, v9
v_mul_f32 v86, v86, v9
v_mul_f32 v87, v87, v9
v_mul_f32 v88, v88, v9
v_mul_f32 v89, v89, v9
v_mul_f32 v90, v90, v9
v_mul_f32 v91, v91, v9
v_mul_f32 v92, v92, v9
v_mul_f32 v93, v93, v9
v_mul_f32 v94, v94, v9
v_mul_f32 v95, v95, v9
v_mul_f32 v96, v96, v9
v_mul_f32 v97, v97, v9
v_mul_f32 v98, v98, v9
v_mul_f32 v99, v99, v9
v_mul_f32 v100, v100, v9
v_mul_f32 v101, v101, v9
v_mul_f32 v102, v102, v9
v_mul_f32 v103, v103, v9
v_mul_f32 v104, v104, v9
v_mul_f32 v105, v105, v9
v_mul_f32 v106, v106, v9
v_mul_f32 v107, v107, v9
v_mul_f32 v108, v108, v9
v_mul_f32 v109, v109, v9
v_mul_f32 v110, v110, v9
v_mul_f32 v111, v111, v9
L_nors1:
v_mul_f32 v7, s76, v5
v_fma_f32 v128, v128, s76, -v7
v_fma_f32 v129, v129, s76, -v7
v_fma_f32 v130, v130, s76, -v7
v_fma_f32 v131, v131, s76, -v7
v_fma_f32 v132, v132, s76, -v7
v_fma_f32 v133, v133, s76, -v7
v_fma_f32 v134, v134, s76, -v7
v_fma_f32 v135, v135, s76, -v7
v_exp_f32 v128, v128
v_exp_f32 v129, v129
v_exp_f32 v130, v130
v_exp_f32 v131, v131
v_exp_f32 v132, v132
v_exp_f32 v133, v133
v_exp_f32 v134, v134
v_exp_f32 v135, v135
s_nop 0
v_cvt_pk_bf16_f32 v140, v128, v129
v_cvt_pk_bf16_f32 v141, v130, v131
v_cvt_pk_bf16_f32 v142, v132, v133
v_cvt_pk_bf16_f32 v143, v134, v135
v_add_f32 v128, v128, v129
v_add_f32 v130, v130, v131
v_add_f32 v132, v132, v133
v_add_f32 v134, v134, v135
v_add_f32 v128, v128, v130
v_add_f32 v132, v132, v134
v_add_f32 v128, v128, v132
v_add_f32 v6, v6, v128

    s_cmp_lg_u32 s81, 0
    s_cbranch_scc1 L_s1d1
    s_sub_u32 s61, s61, 1
    s_cbranch_scc1 L_s1t1
    s_add_u32 s82, s82, 0x200000
    s_and_b32 s82, s82, 0xffffff
s_add_u32 m0, s62, 8192
s_waitcnt vmcnt(15)
buffer_load_dwordx4 v160, s[36:39], s82 offen offset:0 nt lds
s_waitcnt vmcnt(15)
buffer_load_dwordx4 v161, s[36:39], s82 offen offset:1024 nt lds
s_waitcnt vmcnt(15)
buffer_load_dwordx4 v162, s[36:39], s82 offen offset:2048 nt lds
s_waitcnt vmcnt(15)
buffer_load_dwordx4 v163, s[36:39], s82 offen offset:3072 nt lds
s_add_u32 m0, s62, 12288
s_add_u32 s70, s82, 4096
s_waitcnt vmcnt(15)
buffer_load_dwordx4 v160, s[36:39], s70 offen offset:0 nt lds
s_waitcnt vmcnt(15)
buffer_load_dwordx4 v161, s[36:39], s70 offen offset:1024 nt lds
s_waitcnt vmcnt(15)
buffer_load_dwordx4 v162, s[36:39], s70 offen offset:2048 nt lds
s_waitcnt vmcnt(15)
buffer_load_dwordx4 v163, s[36:39], s70 offen offset:3072 nt lds
L_s1r1:
s_waitcnt vmcnt(16)
L_pv1:
v_perm_b32 v112, v52, v48, s73
v_perm_b32 v113, v60, v56, s73
v_perm_b32 v114, v68, v64, s73
v_perm_b32 v115, v76, v72, s73
v_perm_b32 v116, v52, v48, s74
v_perm_b32 v117, v60, v56, s74
v_perm_b32 v118, v68, v64, s74
v_perm_b32 v119, v76, v72, s74
v_mfma_f32_16x16x32_bf16 v[80:83], v[112:115], v[140:143], v[80:83]
v_perm_b32 v120, v53, v49, s73
v_perm_b32 v121, v61, v57, s73
v_perm_b32 v122, v69, v65, s73
v_perm_b32 v123, v77, v73, s73
v_mfma_f32_16x16x32_bf16 v[84:87], v[116:119], v[140:143], v[84:87]
v_perm_b32 v124, v53, v49, s74
v_perm_b32 v125, v61, v57, s74
v_perm_b32 v126, v69, v65, s74
v_perm_b32 v127, v77, v73, s74
v_mfma_f32_16x16x32_bf16 v[88:91], v[120:123], v[140:143], v[88:91]
v_perm_b32 v112, v54, v50, s73
v_perm_b32 v113, v62, v58, s73
v_perm_b32 v114, v70, v66, s73
v_perm_b32 v115, v78, v74, s73
v_mfma_f32_16x16x32_bf16 v[92:95], v[124:127], v[140:143], v[92:95]
v_perm_b32 v116, v54, v50, s74
v_perm_b32 v117, v62, v58, s74
v_perm_b32 v118, v70, v66, s74
v_perm_b32 v119, v78, v74, s74
v_mfma_f32_16x16x32_bf16 v[96:99], v[112:115], v[140:143], v[96:99]
v_perm_b32 v120, v55, v51, s73
v_perm_b32 v121, v63, v59, s73
v_perm_b32 v122, v71, v67, s73
v_perm_b32 v123, v79, v75, s73
v_mfma_f32_16x16x32_bf16 v[100:103], v[116:119], v[140:143], v[100:103]
v_perm_b32 v124, v55, v51, s74
v_perm_b32 v125, v63, v59, s74
v_perm_b32 v126, v71, v67, s74
v_perm_b32 v127, v79, v75, s74
v_mfma_f32_16x16x32_bf16 v[104:107], v[120:123], v[140:143], v[104:107]
s_nop 1
v_mfma_f32_16x16x32_bf16 v[108:111], v[124:127], v[140:143], v[108:111]
s_cmp_lg_u32 s81, 0
s_cbranch_scc1 L_s2d1
s_waitcnt vmcnt(15)
buffer_load_dwordx4 v[48:51], v2, s[40:43], s82 offen offset:0 nt
s_waitcnt vmcnt(15)
buffer_load_dwordx4 v[52:55], v2, s[40:43], s82 offen offset:1024 nt
s_waitcnt vmcnt(15)
buffer_load_dwordx4 v[56:59], v2, s[40:43], s82 offen offset:2048 nt
s_waitcnt vmcnt(15)
buffer_load_dwordx4 v[60:63], v2, s[40:43], s82 offen offset:3072 nt
s_add_u32 s70, s82, 4096
s_waitcnt vmcnt(15)
buffer_load_dwordx4 v[64:67], v2, s[40:43], s70 offen offset:0 nt
s_waitcnt vmcnt(15)
buffer_load_dwordx4 v[68:71], v2, s[40:43], s70 offen offset:1024 nt
s_waitcnt vmcnt(15)
buffer_load_dwordx4 v[72:75], v2, s[40:43], s70 offen offset:2048 nt
s_waitcnt vmcnt(15)
buffer_load_dwordx4 v[76:79], v2, s[40:43], s70 offen offset:3072 nt
s_branch L_top0
L_s1t0:
    s_mov_b32 s81, 1
    s_branch L_s1r0
L_s1d0:
    s_waitcnt lgkmcnt(0)
    s_add_u32 s82, s60, 384
    s_lshl_b32 s82, s82, 1
    s_cmp_lt_u32 s60, 128
    s_cbranch_scc1 L_fullc0
    s_add_u32 s82, s60, 896
    s_cmp_ge_u32 s82, 1024
    s_cbranch_scc1 L_last0
    s_mov_b32 s68, 1
L_fullc0:
    s_and_b32 s78, s82, 1
    s_lshr_b32 s82, s82, 1
    s_lshl_b32 s82, s82, 3
    s_add_u32 s82, s82, s78
    s_lshl_b32 s82, s82, 12
    s_add_u32 s82, s82, s71
    s_and_b32 s82, s82, 0xffffff
s_add_u32 m0, s62, 0
s_waitcnt vmcnt(7)
buffer_load_dwordx4 v160, s[36:39], s82 offen offset:0 nt lds
s_waitcnt vmcnt(7)
buffer_load_dwordx4 v161, s[36:39], s82 offen offset:1024 nt lds
s_waitcnt vmcnt(7)
buffer_load_dwordx4 v162, s[36:39], s82 offen offset:2048 nt lds
s_waitcnt vmcnt(7)
buffer_load_dwordx4 v163, s[36:39], s82 offen offset:3072 nt lds
s_cmp_eq_u32 s68, 0
s_cbranch_scc1 L_k20
s_waitcnt vmcnt(4)
s_branch L_pv0
L_k20:
s_add_u32 m0, s62, 4096
s_add_u32 s70, s82, 4096
s_waitcnt vmcnt(7)
buffer_load_dwordx4 v160, s[36:39], s70 offen offset:0 nt lds
s_waitcnt vmcnt(7)
buffer_load_dwordx4 v161, s[36:39], s70 offen offset:1024 nt lds
s_waitcnt vmcnt(7)
buffer_load_dwordx4 v162, s[36:39], s70 offen offset:2048 nt lds
s_waitcnt vmcnt(7)
buffer_load_dwordx4 v163, s[36:39], s70 offen offset:3072 nt lds
s_waitcnt vmcnt(8)
s_branch L_pv0
L_last0:
s_mov_b32 s81, 3
v_mov_b32 v15, v6
s_nop 1
v_permlane16_swap_b32 v6, v15
s_nop 1
v_add_f32 v6, v6, v15
v_mov_b32 v15, v6
s_nop 1
v_permlane32_swap_b32 v6, v15
s_nop 1
v_add_f32 v6, v6, v15
s_mov_b64 exec, 0xff
ds_write2_b32 v4, v5, v6 offset0:64 offset1:65
s_mov_b64 exec, -1
s_add_u32 m0, s63, 0
s_movk_i32 s70, 0
s_waitcnt vmcnt(3)
buffer_load_dwordx4 v2, s[56:59], s70 offen offset:0 nt lds
s_waitcnt vmcnt(3)
buffer_load_dwordx4 v2, s[56:59], s70 offen offset:1024 nt lds
s_add_u32 m0, s63, 8448
s_movk_i32 s70, 2048
s_waitcnt vmcnt(3)
buffer_load_dwordx4 v2, s[56:59], s70 offen offset:0 nt lds
s_waitcnt vmcnt(3)
buffer_load_dwordx4 v2, s[56:59], s70 offen offset:1024 nt lds
s_waitcnt vmcnt(4)
s_branch L_pv0
L_s2d0:
    s_cmp_eq_u32 s81, 2
    s_cbranch_scc1 L_s2m0
    s_cmp_eq_u32 s81, 3
    s_cbranch_scc1 L_exit
    s_mov_b32 s81, 2
s_barrier
ds_read_b128 a[32:35], v10 offset:0
ds_read_b128 a[36:39], v10 offset:64
ds_read_b128 a[40:43], v10 offset:128
ds_read_b128 a[44:47], v10 offset:192
s_sub_u32 s78, s69, s62
v_add_u32 v112, s78, v164
v_add_u32 v113, s78, v165
v_add_u32 v114, s78, v166
v_add_u32 v115, s78, v167
s_waitcnt vmcnt(32)
ds_read_b128 a[0:3], v112 offset:0
ds_read_b128 a[4:7], v113 offset:0
ds_read_b128 a[8:11], v114 offset:0
ds_read_b128 a[12:15], v115 offset:0
s_waitcnt lgkmcnt(3)
v_mfma_f32_16x16x32_bf16 v[128:131], a[0:3], a[32:35], 0
s_waitcnt lgkmcnt(2)
v_mfma_f32_16x16x32_bf16 v[128:131], a[4:7], a[36:39], v[128:131]
s_waitcnt lgkmcnt(1)
v_mfma_f32_16x16x32_bf16 v[128:131], a[8:11], a[40:43], v[128:131]
s_waitcnt lgkmcnt(0)
v_mfma_f32_16x16x32_bf16 v[128:131], a[12:15], a[44:47], v[128:131]
s_nop 7
v_cvt_pk_bf16_f32 v136, v128, v129
v_cvt_pk_bf16_f32 v137, v130, v131
v_lshlrev_b32 v128, 16, v136
v_and_b32 v129, s77, v136
v_lshlrev_b32 v130, 16, v137
v_and_b32 v131, s77, v137
v_mul_f32 v128, s75, v128
v_mul_f32 v129, s75, v129
v_mul_f32 v130, s75, v130
v_mul_f32 v131, s75, v131
v_cvt_pk_bf16_f32 v136, v128, v129
v_cvt_pk_bf16_f32 v137, v130, v131
v_lshlrev_b32 v128, 16, v136
v_and_b32 v129, s77, v136
v_lshlrev_b32 v130, 16, v137
v_and_b32 v131, s77, v137
v_max3_f32 v8, v128, v129, v130
v_max_f32 v8, v8, v131
v_mov_b32 v15, v8
s_nop 1
v_permlane16_swap_b32 v8, v15
s_nop 1
v_max_f32 v8, v8, v15
v_mov_b32 v15, v8
s_nop 1
v_permlane32_swap_b32 v8, v15
s_nop 1
v_max_f32 v8, v8, v15
v_mul_f32 v7, s76, v8
v_fma_f32 v128, v128, s76, -v7
v_fma_f32 v129, v129, s76, -v7
v_fma_f32 v130, v130, s76, -v7
v_fma_f32 v131, v131, s76, -v7
v_exp_f32 v128, v128
v_exp_f32 v129, v129
v_exp_f32 v130, v130
v_exp_f32 v131, v131
s_nop 0
v_cvt_pk_bf16_f32 v140, v128, v129
v_cvt_pk_bf16_f32 v141, v130, v131
v_add_f32 v132, v128, v129
v_add_f32 v132, v132, v130
v_add_f32 v132, v132, v131
v_perm_b32 v112, v148, v144, s73
v_perm_b32 v113, v156, v152, s73
v_perm_b32 v116, v148, v144, s74
v_perm_b32 v117, v156, v152, s74
s_nop 0
v_mfma_f32_16x16x16_bf16 v[16:19], v[112:113], v[140:141], 0
v_perm_b32 v120, v149, v145, s73
v_perm_b32 v121, v157, v153, s73
s_nop 0
v_mfma_f32_16x16x16_bf16 v[20:23], v[116:117], v[140:141], 0
v_perm_b32 v124, v149, v145, s74
v_perm_b32 v125, v157, v153, s74
s_nop 0
v_mfma_f32_16x16x16_bf16 v[24:27], v[120:121], v[140:141], 0
v_perm_b32 v112, v150, v146, s73
v_perm_b32 v113, v158, v154, s73
s_nop 0
v_mfma_f32_16x16x16_bf16 v[28:31], v[124:125], v[140:141], 0
v_perm_b32 v116, v150, v146, s74
v_perm_b32 v117, v158, v154, s74
s_nop 0
v_mfma_f32_16x16x16_bf16 v[32:35], v[112:113], v[140:141], 0
v_perm_b32 v120, v151, v147, s73
v_perm_b32 v121, v159, v155, s73
s_nop 0
v_mfma_f32_16x16x16_bf16 v[36:39], v[116:117], v[140:141], 0
v_perm_b32 v124, v151, v147, s74
v_perm_b32 v125, v159, v155, s74
s_nop 0
v_mfma_f32_16x16x16_bf16 v[40:43], v[120:121], v[140:141], 0
s_nop 1
v_mfma_f32_16x16x16_bf16 v[44:47], v[124:125], v[140:141], 0
v_mov_b32 v15, v132
s_nop 1
v_permlane16_swap_b32 v132, v15
s_nop 1
v_add_f32 v132, v132, v15
v_mov_b32 v15, v132
s_nop 1
v_permlane32_swap_b32 v132, v15
s_nop 1
v_add_f32 v132, v132, v15
s_mov_b64 exec, 0xff
ds_write2_b32 v4, v8, v132 offset0:0 offset1:1
s_mov_b64 exec, -1
s_mov_b32 exec_lo, 0x00ff00ff
s_mov_b32 exec_hi, 0x00ff00ff
ds_write_b128 v11, v[16:19] offset:0
ds_write_b128 v11, v[20:23] offset:16
ds_write_b128 v11, v[24:27] offset:32
ds_write_b128 v11, v[28:31] offset:48
ds_write_b128 v11, v[32:35] offset:64
ds_write_b128 v11, v[36:39] offset:80
ds_write_b128 v11, v[40:43] offset:96
ds_write_b128 v11, v[44:47] offset:112
s_mov_b64 exec, -1
v_add_u32 v9, 132608, v12
s_waitcnt lgkmcnt(0)
s_barrier
ds_read_b128 v[112:115], v3 offset:0
ds_read_b128 v[116:119], v3 offset:16
ds_read_b128 v[16:19], v9 offset:0
ds_read_b128 v[20:23], v9 offset:4352
ds_read_b128 v[24:27], v9 offset:8704
ds_read_b128 v[28:31], v9 offset:13056

    s_waitcnt lgkmcnt(4)
    v_max3_f32 v136, v112, v114, v116
    v_max_f32 v136, v136, v118
    v_mul_f32 v7, s76, v136
v_fma_f32 v112, v112, s76, -v7
v_fma_f32 v114, v114, s76, -v7
v_fma_f32 v116, v116, s76, -v7
v_fma_f32 v118, v118, s76, -v7
v_exp_f32 v112, v112
v_exp_f32 v114, v114
v_exp_f32 v116, v116
v_exp_f32 v118, v118
v_mul_f32 v137, v112, v113
v_fmac_f32 v137, v114, v115
v_fmac_f32 v137, v116, v117
v_fmac_f32 v137, v118, v119
v_rcp_f32 v138, v137
v_log_f32 v139, v137
s_waitcnt lgkmcnt(0)
v_pk_mul_f32 v[128:129], v[16:17], v[112:113] op_sel_hi:[1,0]
v_pk_mul_f32 v[130:131], v[18:19], v[112:113] op_sel_hi:[1,0]
v_pk_fma_f32 v[128:129], v[20:21], v[114:115], v[128:129] op_sel_hi:[1,0,1]
v_pk_fma_f32 v[130:131], v[22:23], v[114:115], v[130:131] op_sel_hi:[1,0,1]
v_pk_fma_f32 v[128:129], v[24:25], v[116:117], v[128:129] op_sel_hi:[1,0,1]
v_pk_fma_f32 v[130:131], v[26:27], v[116:117], v[130:131] op_sel_hi:[1,0,1]
v_pk_fma_f32 v[128:129], v[28:29], v[118:119], v[128:129] op_sel_hi:[1,0,1]
v_pk_fma_f32 v[130:131], v[30:31], v[118:119], v[130:131] op_sel_hi:[1,0,1]
v_add_f32 v139, v139, v7
v_pk_mul_f32 v[128:129], v[128:129], v[138:139] op_sel_hi:[1,0]
v_pk_mul_f32 v[130:131], v[130:131], v[138:139] op_sel_hi:[1,0]
v_add_u32 v139, 0x80, v139
v_bfi_b32 v128, s19, v1, v128
v_bfi_b32 v129, s19, v1, v129
v_bfi_b32 v130, s19, v1, v130
v_bfi_b32 v131, s19, v1, v131
v_bfi_b32 v139, s19, v1, v139

    buffer_store_dwordx4 v[128:131], v13, s[64:67], s12 offen sc1
    s_mov_b32 exec_lo, 1
    s_mov_b32 exec_hi, 1
    buffer_store_dword v139, v169, s[64:67], s13 offen sc1
s_mov_b64 exec, -1
s_mov_b32 s60, 1
    s_atomic_add s60, s[34:35], 0 glc
    s_branch L_top1
L_s2m0:
s_waitcnt vmcnt(7)
buffer_load_dwordx4 v[16:19], v2, s[40:43], s82 offen offset:0 nt
s_waitcnt vmcnt(7)
buffer_load_dwordx4 v[20:23], v2, s[40:43], s82 offen offset:1024 nt
s_waitcnt vmcnt(7)
buffer_load_dwordx4 v[24:27], v2, s[40:43], s82 offen offset:2048 nt
s_waitcnt vmcnt(7)
buffer_load_dwordx4 v[28:31], v2, s[40:43], s82 offen offset:3072 nt
s_mov_b32 s60, 1
s_atomic_add s60, s[34:35], 0 glc
s_cmp_eq_u32 s68, 0
s_cbranch_scc0 L_top0
s_add_u32 s70, s82, 4096
s_waitcnt vmcnt(7)
buffer_load_dwordx4 v[32:35], v2, s[40:43], s70 offen offset:0 nt
s_waitcnt vmcnt(7)
buffer_load_dwordx4 v[36:39], v2, s[40:43], s70 offen offset:1024 nt
s_waitcnt vmcnt(7)
buffer_load_dwordx4 v[40:43], v2, s[40:43], s70 offen offset:2048 nt
s_waitcnt vmcnt(7)
buffer_load_dwordx4 v[44:47], v2, s[40:43], s70 offen offset:3072 nt
s_branch L_top0
L_s1t1:
    s_mov_b32 s81, 1
    s_branch L_s1r1
L_s1d1:
    s_waitcnt lgkmcnt(0)
    s_add_u32 s82, s60, 384
    s_lshl_b32 s82, s82, 1
    s_cmp_lt_u32 s60, 128
    s_cbranch_scc1 L_fullc1
    s_add_u32 s82, s60, 896
    s_cmp_ge_u32 s82, 1024
    s_cbranch_scc1 L_last1
    s_mov_b32 s68, 1
L_fullc1:
    s_and_b32 s78, s82, 1
    s_lshr_b32 s82, s82, 1
    s_lshl_b32 s82, s82, 3
    s_add_u32 s82, s82, s78
    s_lshl_b32 s82, s82, 12
    s_add_u32 s82, s82, s71
    s_and_b32 s82, s82, 0xffffff
s_add_u32 m0, s62, 8192
s_waitcnt vmcnt(7)
buffer_load_dwordx4 v160, s[36:39], s82 offen offset:0 nt lds
s_waitcnt vmcnt(7)
buffer_load_dwordx4 v161, s[36:39], s82 offen offset:1024 nt lds
s_waitcnt vmcnt(7)
buffer_load_dwordx4 v162, s[36:39], s82 offen offset:2048 nt lds
s_waitcnt vmcnt(7)
buffer_load_dwordx4 v163, s[36:39], s82 offen offset:3072 nt lds
s_cmp_eq_u32 s68, 0
s_cbranch_scc1 L_k21
s_waitcnt vmcnt(4)
s_branch L_pv1
L_k21:
s_add_u32 m0, s62, 12288
s_add_u32 s70, s82, 4096
s_waitcnt vmcnt(7)
buffer_load_dwordx4 v160, s[36:39], s70 offen offset:0 nt lds
s_waitcnt vmcnt(7)
buffer_load_dwordx4 v161, s[36:39], s70 offen offset:1024 nt lds
s_waitcnt vmcnt(7)
buffer_load_dwordx4 v162, s[36:39], s70 offen offset:2048 nt lds
s_waitcnt vmcnt(7)
buffer_load_dwordx4 v163, s[36:39], s70 offen offset:3072 nt lds
s_waitcnt vmcnt(8)
s_branch L_pv1
L_last1:
s_mov_b32 s81, 3
v_mov_b32 v15, v6
s_nop 1
v_permlane16_swap_b32 v6, v15
s_nop 1
v_add_f32 v6, v6, v15
v_mov_b32 v15, v6
s_nop 1
v_permlane32_swap_b32 v6, v15
s_nop 1
v_add_f32 v6, v6, v15
s_mov_b64 exec, 0xff
ds_write2_b32 v4, v5, v6 offset0:64 offset1:65
s_mov_b64 exec, -1
s_add_u32 m0, s63, 0
s_movk_i32 s70, 0
s_waitcnt vmcnt(3)
buffer_load_dwordx4 v2, s[56:59], s70 offen offset:0 nt lds
s_waitcnt vmcnt(3)
buffer_load_dwordx4 v2, s[56:59], s70 offen offset:1024 nt lds
s_add_u32 m0, s63, 8448
s_movk_i32 s70, 2048
s_waitcnt vmcnt(3)
buffer_load_dwordx4 v2, s[56:59], s70 offen offset:0 nt lds
s_waitcnt vmcnt(3)
buffer_load_dwordx4 v2, s[56:59], s70 offen offset:1024 nt lds
s_waitcnt vmcnt(4)
s_branch L_pv1
L_s2d1:
    s_cmp_eq_u32 s81, 2
    s_cbranch_scc1 L_s2m1
    s_cmp_eq_u32 s81, 3
    s_cbranch_scc1 L_exit
    s_mov_b32 s81, 2
s_mov_b32 s60, 1
    s_atomic_add s60, s[34:35], 0 glc
    s_branch L_top0
L_s2m1:
s_waitcnt vmcnt(7)
buffer_load_dwordx4 v[48:51], v2, s[40:43], s82 offen offset:0 nt
s_waitcnt vmcnt(7)
buffer_load_dwordx4 v[52:55], v2, s[40:43], s82 offen offset:1024 nt
s_waitcnt vmcnt(7)
buffer_load_dwordx4 v[56:59], v2, s[40:43], s82 offen offset:2048 nt
s_waitcnt vmcnt(7)
buffer_load_dwordx4 v[60:63], v2, s[40:43], s82 offen offset:3072 nt
s_mov_b32 s60, 1
s_atomic_add s60, s[34:35], 0 glc
s_cmp_eq_u32 s68, 0
s_cbranch_scc0 L_top1
s_add_u32 s70, s82, 4096
s_waitcnt vmcnt(7)
buffer_load_dwordx4 v[64:67], v2, s[40:43], s70 offen offset:0 nt
s_waitcnt vmcnt(7)
buffer_load_dwordx4 v[68:71], v2, s[40:43], s70 offen offset:1024 nt
s_waitcnt vmcnt(7)
buffer_load_dwordx4 v[72:75], v2, s[40:43], s70 offen offset:2048 nt
s_waitcnt vmcnt(7)
buffer_load_dwordx4 v[76:79], v2, s[40:43], s70 offen offset:3072 nt
s_branch L_top1
L_exit:
s_mov_b32 exec_lo, 0x00ff00ff
s_mov_b32 exec_hi, 0x00ff00ff
ds_write_b128 v168, v[80:83] offset:0
ds_write_b128 v168, v[84:87] offset:16
ds_write_b128 v168, v[88:91] offset:32
ds_write_b128 v168, v[92:95] offset:48
ds_write_b128 v168, v[96:99] offset:64
ds_write_b128 v168, v[100:103] offset:80
ds_write_b128 v168, v[104:107] offset:96
ds_write_b128 v168, v[108:111] offset:112
s_mov_b64 exec, -1
s_waitcnt lgkmcnt(0)
s_barrier
s_mov_b64 exec, 1
buffer_store_byte v1, off, s[64:67], s14 sc1
s_mov_b64 exec, -1
ds_read_b128 v[112:115], v3 offset:256
ds_read_b128 v[116:119], v3 offset:272
ds_read_b128 v[80:83], v12 offset:0
ds_read_b128 v[84:87], v12 offset:16384
ds_read_b128 v[88:91], v12 offset:32768
ds_read_b128 v[92:95], v12 offset:49152
s_add_u32 s12, s12, 0x100000
s_add_u32 s13, s13, 32768

    s_waitcnt lgkmcnt(4)
    v_max3_f32 v136, v112, v114, v116
    v_max_f32 v136, v136, v118
    v_mul_f32 v7, s76, v136
v_fma_f32 v112, v112, s76, -v7
v_fma_f32 v114, v114, s76, -v7
v_fma_f32 v116, v116, s76, -v7
v_fma_f32 v118, v118, s76, -v7
v_exp_f32 v112, v112
v_exp_f32 v114, v114
v_exp_f32 v116, v116
v_exp_f32 v118, v118
v_mul_f32 v137, v112, v113
v_fmac_f32 v137, v114, v115
v_fmac_f32 v137, v116, v117
v_fmac_f32 v137, v118, v119
v_rcp_f32 v138, v137
v_log_f32 v139, v137
s_waitcnt lgkmcnt(0)
v_pk_mul_f32 v[128:129], v[80:81], v[112:113] op_sel_hi:[1,0]
v_pk_mul_f32 v[130:131], v[82:83], v[112:113] op_sel_hi:[1,0]
v_pk_fma_f32 v[128:129], v[84:85], v[114:115], v[128:129] op_sel_hi:[1,0,1]
v_pk_fma_f32 v[130:131], v[86:87], v[114:115], v[130:131] op_sel_hi:[1,0,1]
v_pk_fma_f32 v[128:129], v[88:89], v[116:117], v[128:129] op_sel_hi:[1,0,1]
v_pk_fma_f32 v[130:131], v[90:91], v[116:117], v[130:131] op_sel_hi:[1,0,1]
v_pk_fma_f32 v[128:129], v[92:93], v[118:119], v[128:129] op_sel_hi:[1,0,1]
v_pk_fma_f32 v[130:131], v[94:95], v[118:119], v[130:131] op_sel_hi:[1,0,1]
v_add_f32 v139, v139, v7
v_pk_mul_f32 v[128:129], v[128:129], v[138:139] op_sel_hi:[1,0]
v_pk_mul_f32 v[130:131], v[130:131], v[138:139] op_sel_hi:[1,0]
v_add_u32 v139, 0x80, v139
v_bfi_b32 v128, s19, v1, v128
v_bfi_b32 v129, s19, v1, v129
v_bfi_b32 v130, s19, v1, v130
v_bfi_b32 v131, s19, v1, v131
v_bfi_b32 v139, s19, v1, v139

    buffer_store_dwordx4 v[128:131], v13, s[64:67], s12 offen sc1
    s_mov_b32 exec_lo, 1
    s_mov_b32 exec_hi, 1
    buffer_store_dword v139, v169, s[64:67], s13 offen sc1
s_mov_b64 exec, -1
s_add_u32 m0, s63, 16768
s_movk_i32 s70, 4096
s_waitcnt vmcnt(8)
buffer_load_dwordx4 v2, s[56:59], s70 offen offset:0 nt lds
s_waitcnt vmcnt(8)
buffer_load_dwordx4 v2, s[56:59], s70 offen offset:1024 nt lds
s_add_u32 m0, s63, 25216
s_movk_i32 s70, 6144
s_waitcnt vmcnt(8)
buffer_load_dwordx4 v2, s[56:59], s70 offen offset:0 nt lds
s_waitcnt vmcnt(8)
buffer_load_dwordx4 v2, s[56:59], s70 offen offset:1024 nt lds
s_add_u32 m0, s63, 33536
s_movk_i32 s70, 8192
s_waitcnt vmcnt(8)
buffer_load_dwordx4 v2, s[56:59], s70 offen offset:0 nt lds
s_waitcnt vmcnt(8)
buffer_load_dwordx4 v2, s[56:59], s70 offen offset:1024 nt lds
s_add_u32 m0, s63, 41984
s_movk_i32 s70, 10240
s_waitcnt vmcnt(8)
buffer_load_dwordx4 v2, s[56:59], s70 offen offset:0 nt lds
s_waitcnt vmcnt(8)
buffer_load_dwordx4 v2, s[56:59], s70 offen offset:1024 nt lds
s_add_u32 m0, s63, 50304
s_movk_i32 s70, 12288
s_waitcnt vmcnt(8)
buffer_load_dwordx4 v2, s[56:59], s70 offen offset:0 nt lds
s_waitcnt vmcnt(8)
buffer_load_dwordx4 v2, s[56:59], s70 offen offset:1024 nt lds
s_add_u32 m0, s63, 58752
s_movk_i32 s70, 14336
s_waitcnt vmcnt(8)
buffer_load_dwordx4 v2, s[56:59], s70 offen offset:0 nt lds
s_waitcnt vmcnt(8)
buffer_load_dwordx4 v2, s[56:59], s70 offen offset:1024 nt lds
s_mov_b32 s52, s24
s_mov_b32 s53, s25
s_movk_i32 s54, 0x1000
s_mov_b32 s55, 0x20000
s_mov_b32 s81, 0
v_lshrrev_b32 v8, 4, v0
v_and_b32 v9, 15, v0
v_lshlrev_b32 v172, 8, v8
v_lshl_add_u32 v172, v9, 2, v172
s_mov_b64 exec, 1
s_waitcnt vmcnt(0)
s_barrier
buffer_store_byte v1, v174, s[64:67], s16 offen sc1
s_mov_b64 exec, -1
ds_read_b128 v[148:151], v171
ds_read_b64_tr_b16 v[16:17], v170 offset:0
ds_read_b64_tr_b16 v[18:19], v170 offset:8448
ds_read_b64_tr_b16 v[20:21], v170 offset:32
ds_read_b64_tr_b16 v[22:23], v170 offset:8480
ds_read_b64_tr_b16 v[24:25], v170 offset:64
ds_read_b64_tr_b16 v[26:27], v170 offset:8512
ds_read_b64_tr_b16 v[28:29], v170 offset:96
ds_read_b64_tr_b16 v[30:31], v170 offset:8544
ds_read_b64_tr_b16 v[32:33], v170 offset:128
ds_read_b64_tr_b16 v[34:35], v170 offset:8576
s_waitcnt lgkmcnt(8)
v_mfma_f32_16x16x32_bf16 v[80:83], v[148:151], v[16:19], 0
ds_read_b64_tr_b16 v[36:37], v170 offset:160
ds_read_b64_tr_b16 v[38:39], v170 offset:8608
s_waitcnt lgkmcnt(8)
v_mfma_f32_16x16x32_bf16 v[84:87], v[148:151], v[20:23], 0
ds_read_b64_tr_b16 v[40:41], v170 offset:192
ds_read_b64_tr_b16 v[42:43], v170 offset:8640
s_waitcnt lgkmcnt(8)
v_mfma_f32_16x16x32_bf16 v[88:91], v[148:151], v[24:27], 0
ds_read_b64_tr_b16 v[44:45], v170 offset:224
ds_read_b64_tr_b16 v[46:47], v170 offset:8672
s_waitcnt lgkmcnt(8)
v_mfma_f32_16x16x32_bf16 v[92:95], v[148:151], v[28:31], 0
ds_read_b64_tr_b16 v[48:49], v170 offset:256
ds_read_b64_tr_b16 v[50:51], v170 offset:8704
s_waitcnt lgkmcnt(8)
v_mfma_f32_16x16x32_bf16 v[96:99], v[148:151], v[32:35], 0
ds_read_b64_tr_b16 v[52:53], v170 offset:288
ds_read_b64_tr_b16 v[54:55], v170 offset:8736
s_waitcnt lgkmcnt(8)
v_mfma_f32_16x16x32_bf16 v[100:103], v[148:151], v[36:39], 0
ds_read_b64_tr_b16 v[56:57], v170 offset:320
ds_read_b64_tr_b16 v[58:59], v170 offset:8768
s_waitcnt lgkmcnt(8)
v_mfma_f32_16x16x32_bf16 v[104:107], v[148:151], v[40:43], 0
ds_read_b64_tr_b16 v[60:61], v170 offset:352
ds_read_b64_tr_b16 v[62:63], v170 offset:8800
s_waitcnt lgkmcnt(8)
v_mfma_f32_16x16x32_bf16 v[108:111], v[148:151], v[44:47], 0
ds_read_b64_tr_b16 v[64:65], v170 offset:384
ds_read_b64_tr_b16 v[66:67], v170 offset:8832
s_waitcnt lgkmcnt(8)
v_mfma_f32_16x16x32_bf16 v[112:115], v[148:151], v[48:51], 0
ds_read_b64_tr_b16 v[68:69], v170 offset:416
ds_read_b64_tr_b16 v[70:71], v170 offset:8864
s_waitcnt lgkmcnt(8)
v_mfma_f32_16x16x32_bf16 v[116:119], v[148:151], v[52:55], 0
ds_read_b64_tr_b16 v[72:73], v170 offset:448
ds_read_b64_tr_b16 v[74:75], v170 offset:8896
s_waitcnt lgkmcnt(8)
v_mfma_f32_16x16x32_bf16 v[120:123], v[148:151], v[56:59], 0
ds_read_b64_tr_b16 v[76:77], v170 offset:480
ds_read_b64_tr_b16 v[78:79], v170 offset:8928
s_waitcnt lgkmcnt(8)
v_mfma_f32_16x16x32_bf16 v[124:127], v[148:151], v[60:63], 0
s_waitcnt lgkmcnt(6)
v_mfma_f32_16x16x32_bf16 v[128:131], v[148:151], v[64:67], 0
s_mov_b64 exec, 0xffff
v_bfi_b32 v144, s19, v1, v80
v_bfi_b32 v145, s19, v1, v84
v_bfi_b32 v146, s19, v1, v88
v_bfi_b32 v147, s19, v1, v92
s_waitcnt lgkmcnt(4)
v_mfma_f32_16x16x32_bf16 v[132:135], v[148:151], v[68:71], 0
s_lshl_b64 exec, exec, 16
v_bfi_b32 v144, s19, v1, v96
v_bfi_b32 v145, s19, v1, v100
v_bfi_b32 v146, s19, v1, v104
v_bfi_b32 v147, s19, v1, v108
s_waitcnt lgkmcnt(2)
v_mfma_f32_16x16x32_bf16 v[136:139], v[148:151], v[72:75], 0
s_waitcnt lgkmcnt(0)
v_mfma_f32_16x16x32_bf16 v[140:143], v[148:151], v[76:79], 0
s_lshl_b64 exec, exec, 16
v_bfi_b32 v144, s19, v1, v112
v_bfi_b32 v145, s19, v1, v116
v_bfi_b32 v146, s19, v1, v120
v_bfi_b32 v147, s19, v1, v124
s_lshl_b64 exec, exec, 16
s_nop 1
v_bfi_b32 v144, s19, v1, v128
v_bfi_b32 v145, s19, v1, v132
v_bfi_b32 v146, s19, v1, v136
v_bfi_b32 v147, s19, v1, v140
s_mov_b64 exec, -1
buffer_store_dword v144, v172, s[64:67], s15 offen offset:0 sc1
buffer_store_dword v145, v172, s[64:67], s15 offen offset:64 sc1
buffer_store_dword v146, v172, s[64:67], s15 offen offset:128 sc1
buffer_store_dword v147, v172, s[64:67], s15 offen offset:192 sc1
s_cmp_ge_u32 s33, 32
    s_cbranch_scc1 L_fin
L_ofpoll:
    s_load_dwordx2 s[40:41], s[4:5], 0 glc
    s_load_dwordx2 s[42:43], s[4:5], 128 glc
    s_load_dwordx2 s[44:45], s[4:5], 256 glc
    s_load_dwordx2 s[46:47], s[4:5], 384 glc
    s_add_u32 s81, s81, 1
    s_cmp_gt_u32 s81, 400000
    s_cbranch_scc1 L_fgather
    s_waitcnt lgkmcnt(0)
    s_xor_b64 s[40:41], s[40:41], s[22:23]
    s_xor_b64 s[42:43], s[42:43], s[22:23]
    s_xor_b64 s[44:45], s[44:45], s[22:23]
    s_xor_b64 s[46:47], s[46:47], s[22:23]
    s_or_b64 s[40:41], s[40:41], s[42:43]
    s_or_b64 s[44:45], s[44:45], s[46:47]
    s_or_b64 s[40:41], s[40:41], s[44:45]
    s_cbranch_scc1 L_ofpoll
L_fgather:
buffer_load_dwordx4 v[16:19], v173, s[64:67], s17 offen sc1
s_add_u32 s79, s17, 32768
buffer_load_dwordx4 v[20:23], v173, s[64:67], s79 offen sc1
s_add_u32 s79, s17, 65536
buffer_load_dwordx4 v[24:27], v173, s[64:67], s79 offen sc1
s_add_u32 s79, s17, 98304
buffer_load_dwordx4 v[28:31], v173, s[64:67], s79 offen sc1
s_add_u32 s81, s81, 1
v_lshlrev_b32 v10, 3, v0
v_add_u32 v10, 157184, v10
v_lshlrev_b32 v11, 2, v0
v_mov_b32 v40, s72
s_waitcnt vmcnt(3)
v_xor_b32 v8, s83, v16
v_xor_b32 v9, s83, v17
v_bitop3_b32 v8, v8, v18, s83 bitop3:0xf6
v_bitop3_b32 v9, v9, v19, s83 bitop3:0xf6
v_and_b32 v16, s20, v16
v_and_b32 v17, s20, v17
v_and_b32 v18, s20, v18
v_and_b32 v19, s20, v19
s_waitcnt vmcnt(2)
v_bitop3_b32 v8, v8, v20, s83 bitop3:0xf6
v_bitop3_b32 v9, v9, v21, s83 bitop3:0xf6
v_bitop3_b32 v8, v8, v22, s83 bitop3:0xf6
v_bitop3_b32 v9, v9, v23, s83 bitop3:0xf6
v_and_b32 v20, s20, v20
v_and_b32 v21, s20, v21
v_and_b32 v22, s20, v22
v_and_b32 v23, s20, v23
v_pk_add_f32 v[16:17], v[16:17], v[20:21]
v_pk_add_f32 v[18:19], v[18:19], v[22:23]
s_waitcnt vmcnt(1)
v_bitop3_b32 v8, v8, v24, s83 bitop3:0xf6
v_bitop3_b32 v9, v9, v25, s83 bitop3:0xf6
v_bitop3_b32 v8, v8, v26, s83 bitop3:0xf6
v_bitop3_b32 v9, v9, v27, s83 bitop3:0xf6
v_and_b32 v24, s20, v24
v_and_b32 v25, s20, v25
v_and_b32 v26, s20, v26
v_and_b32 v27, s20, v27
v_pk_add_f32 v[16:17], v[16:17], v[24:25]
v_pk_add_f32 v[18:19], v[18:19], v[26:27]
s_waitcnt vmcnt(0)
v_bitop3_b32 v8, v8, v28, s83 bitop3:0xf6
v_bitop3_b32 v9, v9, v29, s83 bitop3:0xf6
v_bitop3_b32 v8, v8, v30, s83 bitop3:0xf6
v_bitop3_b32 v9, v9, v31, s83 bitop3:0xf6
v_and_b32 v28, s20, v28
v_and_b32 v29, s20, v29
v_and_b32 v30, s20, v30
v_and_b32 v31, s20, v31
v_pk_add_f32 v[16:17], v[16:17], v[28:29]
v_pk_add_f32 v[18:19], v[18:19], v[30:31]
v_or_b32 v8, v8, v9
    v_and_b32 v8, s19, v8
    v_cmp_ne_u32 vcc, 0, v8
    s_cbranch_vccz L_fok
    s_cmp_gt_u32 s81, 400000
    s_cbranch_scc0 L_fgather
L_fok:
v_add_f32_dpp v16, v16, v16 row_ror:8 row_mask:0xf bank_mask:0xf
v_add_f32_dpp v17, v17, v17 row_ror:8 row_mask:0xf bank_mask:0xf
v_add_f32_dpp v18, v18, v18 row_ror:8 row_mask:0xf bank_mask:0xf
v_add_f32_dpp v19, v19, v19 row_ror:8 row_mask:0xf bank_mask:0xf
v_mov_b32 v20, v16
v_mov_b32 v21, v17
v_mov_b32 v22, v18
v_mov_b32 v23, v19
v_permlane16_swap_b32 v16, v20
v_permlane16_swap_b32 v17, v21
v_permlane16_swap_b32 v18, v22
v_permlane16_swap_b32 v19, v23
v_add_f32 v16, v16, v20
v_add_f32 v17, v17, v21
v_add_f32 v18, v18, v22
v_add_f32 v19, v19, v23
v_mov_b32 v20, v16
v_mov_b32 v21, v17
v_mov_b32 v22, v18
v_mov_b32 v23, v19
v_permlane32_swap_b32 v16, v20
v_permlane32_swap_b32 v17, v21
v_permlane32_swap_b32 v18, v22
v_permlane32_swap_b32 v19, v23
v_add_f32 v16, v16, v20
v_add_f32 v17, v17, v21
v_add_f32 v18, v18, v22
v_add_f32 v19, v19, v23
s_mov_b64 exec, 0xff
    ds_write_b128 v175, v[16:19]
    s_mov_b64 exec, 0xffff
    s_cmp_eq_u32 s3, 0
    s_waitcnt lgkmcnt(0)
    s_barrier
    s_cbranch_scc0 L_fin
    ds_read_b64 v[16:17], v10
    ds_read_b64 v[18:19], v10 offset:128
    ds_read_b64 v[20:21], v10 offset:256
    ds_read_b64 v[22:23], v10 offset:384
    s_cmp_eq_u32 s2, 0
    s_waitcnt lgkmcnt(2)
    v_pk_add_f32 v[16:17], v[16:17], v[18:19]
    s_waitcnt lgkmcnt(0)
    v_pk_add_f32 v[20:21], v[20:21], v[22:23]
    v_pk_add_f32 v[16:17], v[16:17], v[20:21]
    v_cvt_pk_bf16_f32 v16, v16, v17
    buffer_store_dword v16, v11, s[52:55], s18 offen
    s_cbranch_scc0 L_noep
    s_mov_b64 exec, 1
    buffer_store_dword v40, off, s[64:67], 0 sc1
L_noep:
s_branch L_fin
L_sync:
s_setprio 3
v_mov_b32 v16, 0
    v_mov_b32 v20, 157760
    ds_write_b32 v20, v16
s_waitcnt lgkmcnt(0)
s_load_dword s72, s[28:29], 0
s_mov_b32 s64, s28
s_mov_b32 s65, s29
s_mov_b32 s66, 3932160
s_mov_b32 s67, 0x20000

    s_movk_i32 s77, 0xff00
    s_movk_i32 s75, 0xff
    s_and_b32 s36, s33, 0x4f
    s_xor_b32 s37, s32, 1
    s_or_b32 s36, s36, s37
    s_cbranch_scc1 L_nopool
    s_bfe_u32 s36, s33, 0x20004
    s_lshl_b32 s36, s36, 10
    s_add_u32 s36, s36, 81920
    v_lshlrev_b32 v3, 7, v0
    s_mov_b64 exec, 0xff
    buffer_store_dword v16, v3, s[64:67], s36 offen sc1
    s_mov_b64 exec, -1
    s_waitcnt vmcnt(0)
L_nopool:
    v_lshrrev_b32 v3, 5, v0
    v_lshlrev_b32 v3, 5, v3
    v_and_b32 v15, 3, v0
    v_lshl_add_u32 v3, v15, 3, v3
    v_bfe_u32 v15, v0, 2, 3
    v_add_u32 v3, v3, v15
    v_lshlrev_b32 v3, 2, v3
    v_lshlrev_b32 v4, 2, v0
    v_add_u32 v4, 150016, v4
    v_lshrrev_b32 v5, 5, v0
    v_mul_u32_u24 v5, 272, v5
    v_and_b32 v15, 31, v0
    v_lshl_add_u32 v5, v15, 3, v5
    v_add_u32 v5, 152064, v5
s_lshl_b32 s78, s32, 15
s_lshr_b32 s70, s33, 6
s_lshl_b32 s70, s70, 14
s_add_u32 s78, s78, s70
s_and_b32 s70, s33, 63
s_lshl_b32 s70, s70, 8
s_add_u32 s78, s78, s70
s_add_u32 s78, s78, 4096
s_lshl_b32 s80, s30, 12
s_add_u32 s80, s80, 4096

    s_waitcnt lgkmcnt(0)
    s_add_u32 s72, s72, 1
    s_and_b32 s74, s72, 0xff
    s_mul_i32 s82, s74, 0x01010101
    s_mov_b32 s83, s82
    v_mov_b32 v1, s74
    s_barrier
ds_read_b32 v16, v4 offset:0
ds_read_b32 v17, v4 offset:256
ds_read_b32 v18, v4 offset:512
ds_read_b32 v19, v4 offset:768
ds_read_b32 v20, v4 offset:1024
ds_read_b32 v21, v4 offset:1280
ds_read_b32 v22, v4 offset:1536
ds_read_b32 v23, v4 offset:1792

    s_waitcnt lgkmcnt(0)
    v_add_f32 v16, v16, v17
    v_add_f32 v18, v18, v19
    v_add_f32 v20, v20, v21
    v_add_f32 v22, v22, v23
    v_add_f32 v16, v16, v18
    v_add_f32 v20, v20, v22
    v_add_f32 v24, v16, v20
    v_add_u32 v24, 0x80, v24
    v_bfi_b32 v24, s75, v1, v24
    buffer_store_dword v24, v3, s[64:67], s78 offen sc1
    s_mov_b32 s81, 0
    s_barrier
s_add_u32 s70, s80, 32768
buffer_load_dwordx4 v[48:51], v2, s[64:67], s70 offen offset:0 sc1
buffer_load_dwordx4 v[52:55], v2, s[64:67], s70 offen offset:1024 sc1
buffer_load_dwordx4 v[56:59], v2, s[64:67], s70 offen offset:2048 sc1
buffer_load_dwordx4 v[60:63], v2, s[64:67], s70 offen offset:3072 sc1
s_add_u32 s70, s80, 49152
buffer_load_dwordx4 v[64:67], v2, s[64:67], s70 offen offset:0 sc1
buffer_load_dwordx4 v[68:71], v2, s[64:67], s70 offen offset:1024 sc1
buffer_load_dwordx4 v[72:75], v2, s[64:67], s70 offen offset:2048 sc1
buffer_load_dwordx4 v[76:79], v2, s[64:67], s70 offen offset:3072 sc1
s_add_u32 s70, s80, 0
buffer_load_dwordx4 v[16:19], v2, s[64:67], s70 offen offset:0 sc1
buffer_load_dwordx4 v[20:23], v2, s[64:67], s70 offen offset:1024 sc1
buffer_load_dwordx4 v[24:27], v2, s[64:67], s70 offen offset:2048 sc1
buffer_load_dwordx4 v[28:31], v2, s[64:67], s70 offen offset:3072 sc1
s_add_u32 s70, s80, 16384
buffer_load_dwordx4 v[32:35], v2, s[64:67], s70 offen offset:0 sc1
buffer_load_dwordx4 v[36:39], v2, s[64:67], s70 offen offset:1024 sc1
buffer_load_dwordx4 v[40:43], v2, s[64:67], s70 offen offset:2048 sc1
buffer_load_dwordx4 v[44:47], v2, s[64:67], s70 offen offset:3072 sc1
s_waitcnt vmcnt(8)
L_qa:
v_xor_b32 v10, s74, v48
v_xor_b32 v11, s74, v49
v_bitop3_b32 v10, v10, v50, s74 bitop3:0xf6
v_bitop3_b32 v11, v11, v51, s74 bitop3:0xf6
v_bitop3_b32 v10, v10, v52, s74 bitop3:0xf6
v_bitop3_b32 v11, v11, v53, s74 bitop3:0xf6
v_bitop3_b32 v10, v10, v54, s74 bitop3:0xf6
v_bitop3_b32 v11, v11, v55, s74 bitop3:0xf6
v_bitop3_b32 v10, v10, v56, s74 bitop3:0xf6
v_bitop3_b32 v11, v11, v57, s74 bitop3:0xf6
v_bitop3_b32 v10, v10, v58, s74 bitop3:0xf6
v_bitop3_b32 v11, v11, v59, s74 bitop3:0xf6
v_bitop3_b32 v10, v10, v60, s74 bitop3:0xf6
v_bitop3_b32 v11, v11, v61, s74 bitop3:0xf6
v_bitop3_b32 v10, v10, v62, s74 bitop3:0xf6
v_bitop3_b32 v11, v11, v63, s74 bitop3:0xf6
v_bitop3_b32 v10, v10, v64, s74 bitop3:0xf6
v_bitop3_b32 v11, v11, v65, s74 bitop3:0xf6
v_bitop3_b32 v10, v10, v66, s74 bitop3:0xf6
v_bitop3_b32 v11, v11, v67, s74 bitop3:0xf6
v_bitop3_b32 v10, v10, v68, s74 bitop3:0xf6
v_bitop3_b32 v11, v11, v69, s74 bitop3:0xf6
v_bitop3_b32 v10, v10, v70, s74 bitop3:0xf6
v_bitop3_b32 v11, v11, v71, s74 bitop3:0xf6
v_bitop3_b32 v10, v10, v72, s74 bitop3:0xf6
v_bitop3_b32 v11, v11, v73, s74 bitop3:0xf6
v_bitop3_b32 v10, v10, v74, s74 bitop3:0xf6
v_bitop3_b32 v11, v11, v75, s74 bitop3:0xf6
v_bitop3_b32 v10, v10, v76, s74 bitop3:0xf6
v_bitop3_b32 v11, v11, v77, s74 bitop3:0xf6
v_bitop3_b32 v10, v10, v78, s74 bitop3:0xf6
v_bitop3_b32 v11, v11, v79, s74 bitop3:0xf6
s_add_u32 s81, s81, 1
v_or_b32 v10, v10, v11
    v_and_b32 v10, s75, v10
    v_cmp_ne_u32 vcc, 0, v10
    s_cbranch_vccz L_qaok
    s_cmp_gt_u32 s81, 400000
    s_cbranch_scc0 L_qar
L_qaok:
v_and_b32 v48, s77, v48
v_and_b32 v49, s77, v49
v_and_b32 v50, s77, v50
v_and_b32 v51, s77, v51
v_and_b32 v52, s77, v52
v_and_b32 v53, s77, v53
v_and_b32 v54, s77, v54
v_and_b32 v55, s77, v55
v_and_b32 v56, s77, v56
v_and_b32 v57, s77, v57
v_and_b32 v58, s77, v58
v_and_b32 v59, s77, v59
v_and_b32 v60, s77, v60
v_and_b32 v61, s77, v61
v_and_b32 v62, s77, v62
v_and_b32 v63, s77, v63
v_and_b32 v64, s77, v64
v_and_b32 v65, s77, v65
v_and_b32 v66, s77, v66
v_and_b32 v67, s77, v67
v_and_b32 v68, s77, v68
v_and_b32 v69, s77, v69
v_and_b32 v70, s77, v70
v_and_b32 v71, s77, v71
v_and_b32 v72, s77, v72
v_and_b32 v73, s77, v73
v_and_b32 v74, s77, v74
v_and_b32 v75, s77, v75
v_and_b32 v76, s77, v76
v_and_b32 v77, s77, v77
v_and_b32 v78, s77, v78
v_and_b32 v79, s77, v79
v_pk_add_f32 v[48:49], v[48:49], v[64:65]
v_pk_add_f32 v[50:51], v[50:51], v[66:67]
v_cvt_pk_bf16_f32 v48, v48, v49
v_cvt_pk_bf16_f32 v49, v50, v51
ds_write_b64 v5, v[48:49] offset:2176
v_pk_add_f32 v[52:53], v[52:53], v[68:69]
v_pk_add_f32 v[54:55], v[54:55], v[70:71]
v_cvt_pk_bf16_f32 v52, v52, v53
v_cvt_pk_bf16_f32 v53, v54, v55
ds_write_b64 v5, v[52:53] offset:2720
v_pk_add_f32 v[56:57], v[56:57], v[72:73]
v_pk_add_f32 v[58:59], v[58:59], v[74:75]
v_cvt_pk_bf16_f32 v56, v56, v57
v_cvt_pk_bf16_f32 v57, v58, v59
ds_write_b64 v5, v[56:57] offset:3264
v_pk_add_f32 v[60:61], v[60:61], v[76:77]
v_pk_add_f32 v[62:63], v[62:63], v[78:79]
v_cvt_pk_bf16_f32 v60, v60, v61
v_cvt_pk_bf16_f32 v61, v62, v63
ds_write_b64 v5, v[60:61] offset:3808
s_waitcnt lgkmcnt(0)
s_barrier
s_waitcnt vmcnt(0)
L_qb:
v_xor_b32 v10, s74, v16
v_xor_b32 v11, s74, v17
v_bitop3_b32 v10, v10, v18, s74 bitop3:0xf6
v_bitop3_b32 v11, v11, v19, s74 bitop3:0xf6
v_bitop3_b32 v10, v10, v20, s74 bitop3:0xf6
v_bitop3_b32 v11, v11, v21, s74 bitop3:0xf6
v_bitop3_b32 v10, v10, v22, s74 bitop3:0xf6
v_bitop3_b32 v11, v11, v23, s74 bitop3:0xf6
v_bitop3_b32 v10, v10, v24, s74 bitop3:0xf6
v_bitop3_b32 v11, v11, v25, s74 bitop3:0xf6
v_bitop3_b32 v10, v10, v26, s74 bitop3:0xf6
v_bitop3_b32 v11, v11, v27, s74 bitop3:0xf6
v_bitop3_b32 v10, v10, v28, s74 bitop3:0xf6
v_bitop3_b32 v11, v11, v29, s74 bitop3:0xf6
v_bitop3_b32 v10, v10, v30, s74 bitop3:0xf6
v_bitop3_b32 v11, v11, v31, s74 bitop3:0xf6
v_bitop3_b32 v10, v10, v32, s74 bitop3:0xf6
v_bitop3_b32 v11, v11, v33, s74 bitop3:0xf6
v_bitop3_b32 v10, v10, v34, s74 bitop3:0xf6
v_bitop3_b32 v11, v11, v35, s74 bitop3:0xf6
v_bitop3_b32 v10, v10, v36, s74 bitop3:0xf6
v_bitop3_b32 v11, v11, v37, s74 bitop3:0xf6
v_bitop3_b32 v10, v10, v38, s74 bitop3:0xf6
v_bitop3_b32 v11, v11, v39, s74 bitop3:0xf6
v_bitop3_b32 v10, v10, v40, s74 bitop3:0xf6
v_bitop3_b32 v11, v11, v41, s74 bitop3:0xf6
v_bitop3_b32 v10, v10, v42, s74 bitop3:0xf6
v_bitop3_b32 v11, v11, v43, s74 bitop3:0xf6
v_bitop3_b32 v10, v10, v44, s74 bitop3:0xf6
v_bitop3_b32 v11, v11, v45, s74 bitop3:0xf6
v_bitop3_b32 v10, v10, v46, s74 bitop3:0xf6
v_bitop3_b32 v11, v11, v47, s74 bitop3:0xf6
s_add_u32 s81, s81, 1
v_or_b32 v10, v10, v11
    v_and_b32 v10, s75, v10
    v_cmp_ne_u32 vcc, 0, v10
    s_cbranch_vccz L_qbok
    s_cmp_gt_u32 s81, 400000
    s_cbranch_scc0 L_qbr
L_qbok:
v_and_b32 v16, s77, v16
v_and_b32 v17, s77, v17
v_and_b32 v18, s77, v18
v_and_b32 v19, s77, v19
v_and_b32 v20, s77, v20
v_and_b32 v21, s77, v21
v_and_b32 v22, s77, v22
v_and_b32 v23, s77, v23
v_and_b32 v24, s77, v24
v_and_b32 v25, s77, v25
v_and_b32 v26, s77, v26
v_and_b32 v27, s77, v27
v_and_b32 v28, s77, v28
v_and_b32 v29, s77, v29
v_and_b32 v30, s77, v30
v_and_b32 v31, s77, v31
v_and_b32 v32, s77, v32
v_and_b32 v33, s77, v33
v_and_b32 v34, s77, v34
v_and_b32 v35, s77, v35
v_and_b32 v36, s77, v36
v_and_b32 v37, s77, v37
v_and_b32 v38, s77, v38
v_and_b32 v39, s77, v39
v_and_b32 v40, s77, v40
v_and_b32 v41, s77, v41
v_and_b32 v42, s77, v42
v_and_b32 v43, s77, v43
v_and_b32 v44, s77, v44
v_and_b32 v45, s77, v45
v_and_b32 v46, s77, v46
v_and_b32 v47, s77, v47
v_pk_add_f32 v[16:17], v[16:17], v[32:33]
v_pk_add_f32 v[18:19], v[18:19], v[34:35]
v_cvt_pk_bf16_f32 v16, v16, v17
v_cvt_pk_bf16_f32 v17, v18, v19
ds_write_b64 v5, v[16:17] offset:0
v_pk_add_f32 v[20:21], v[20:21], v[36:37]
v_pk_add_f32 v[22:23], v[22:23], v[38:39]
v_cvt_pk_bf16_f32 v20, v20, v21
v_cvt_pk_bf16_f32 v21, v22, v23
ds_write_b64 v5, v[20:21] offset:544
v_pk_add_f32 v[24:25], v[24:25], v[40:41]
v_pk_add_f32 v[26:27], v[26:27], v[42:43]
v_cvt_pk_bf16_f32 v24, v24, v25
v_cvt_pk_bf16_f32 v25, v26, v27
ds_write_b64 v5, v[24:25] offset:1088
v_pk_add_f32 v[28:29], v[28:29], v[44:45]
v_pk_add_f32 v[30:31], v[30:31], v[46:47]
v_cvt_pk_bf16_f32 v28, v28, v29
v_cvt_pk_bf16_f32 v29, v30, v31
ds_write_b64 v5, v[28:29] offset:1632
s_branch L_qdone
L_qar:
s_add_u32 s70, s80, 32768
buffer_load_dwordx4 v[48:51], v2, s[64:67], s70 offen offset:0 sc1
buffer_load_dwordx4 v[52:55], v2, s[64:67], s70 offen offset:1024 sc1
buffer_load_dwordx4 v[56:59], v2, s[64:67], s70 offen offset:2048 sc1
buffer_load_dwordx4 v[60:63], v2, s[64:67], s70 offen offset:3072 sc1
s_add_u32 s70, s80, 49152
buffer_load_dwordx4 v[64:67], v2, s[64:67], s70 offen offset:0 sc1
buffer_load_dwordx4 v[68:71], v2, s[64:67], s70 offen offset:1024 sc1
buffer_load_dwordx4 v[72:75], v2, s[64:67], s70 offen offset:2048 sc1
buffer_load_dwordx4 v[76:79], v2, s[64:67], s70 offen offset:3072 sc1
s_waitcnt vmcnt(0)
s_branch L_qa
L_qbr:
s_add_u32 s70, s80, 0
buffer_load_dwordx4 v[16:19], v2, s[64:67], s70 offen offset:0 sc1
buffer_load_dwordx4 v[20:23], v2, s[64:67], s70 offen offset:1024 sc1
buffer_load_dwordx4 v[24:27], v2, s[64:67], s70 offen offset:2048 sc1
buffer_load_dwordx4 v[28:31], v2, s[64:67], s70 offen offset:3072 sc1
s_add_u32 s70, s80, 16384
buffer_load_dwordx4 v[32:35], v2, s[64:67], s70 offen offset:0 sc1
buffer_load_dwordx4 v[36:39], v2, s[64:67], s70 offen offset:1024 sc1
buffer_load_dwordx4 v[40:43], v2, s[64:67], s70 offen offset:2048 sc1
buffer_load_dwordx4 v[44:47], v2, s[64:67], s70 offen offset:3072 sc1
s_waitcnt vmcnt(0)
s_branch L_qb
L_qdone:
s_waitcnt lgkmcnt(0)
s_barrier
s_barrier
s_lshl_b32 s78, s32, 20
s_lshr_b32 s70, s33, 5
s_lshl_b32 s70, s70, 18
s_add_u32 s78, s78, s70
s_and_b32 s70, s33, 31
s_lshl_b32 s70, s70, 7
s_add_u32 s78, s78, s70
s_add_u32 s78, s78, 262144
s_lshl_b32 s79, s32, 15
s_lshr_b32 s70, s33, 2
s_lshl_b32 s70, s70, 10
s_add_u32 s79, s79, s70
s_add_u32 s79, s79, 3670016
s_lshr_b32 s80, s33, 3
s_lshl_b32 s80, s80, 11
s_add_u32 s80, s80, 3473408

    s_add_u32 s38, s28, s80
    s_addc_u32 s39, s29, 0
    s_add_u32 s36, s28, s79
    s_addc_u32 s37, s29, 0
    v_lshrrev_b32 v15, 3, v0
    v_lshlrev_b32 v5, 12, v15
    v_and_b32 v13, 7, v0
    v_lshl_add_u32 v5, v13, 4, v5
    v_lshlrev_b32 v14, 7, v15
    v_lshl_add_u32 v14, v13, 2, v14
    v_lshlrev_b32 v3, 3, v0
    v_add_u32 v3, 157696, v3
    v_lshlrev_b32 v6, 5, v13
    v_lshl_add_u32 v6, v15, 2, v6
    v_add_u32 v6, 156928, v6
    v_lshlrev_b32 v7, 5, v15
    v_add_u32 v7, 156928, v7

    s_mov_b32 s81, 0
    s_cmp_eq_u32 s32, 0
    s_cbranch_scc1 L_nowarm1
s_load_dword s40, s[38:39], 0 glc
s_load_dword s41, s[38:39], 128 glc
s_load_dword s42, s[38:39], 256 glc
s_load_dword s43, s[38:39], 384 glc
s_load_dword s48, s[36:37], 0 glc
s_load_dword s49, s[36:37], 128 glc
s_load_dword s50, s[36:37], 256 glc
s_load_dword s51, s[36:37], 384 glc
s_load_dword s52, s[36:37], 512 glc
s_load_dword s53, s[36:37], 640 glc
s_load_dword s54, s[36:37], 768 glc
s_load_dword s55, s[36:37], 896 glc
L_nowarm1:
s_waitcnt lgkmcnt(0)
s_barrier
s_cmp_eq_u32 s32, 0
s_cbranch_scc1 L_pgather
L_sppoll:
s_load_dwordx4 s[40:43], s[38:39], 0 glc
s_load_dwordx4 s[44:47], s[38:39], 128 glc
s_load_dwordx4 s[48:51], s[38:39], 256 glc
s_load_dwordx4 s[52:55], s[38:39], 384 glc
s_add_u32 s81, s81, 1
s_cmp_gt_u32 s81, 400000
s_cbranch_scc1 L_pgather
s_waitcnt lgkmcnt(0)
s_xor_b64 s[40:41], s[40:41], s[82:83]
s_xor_b64 s[42:43], s[42:43], s[82:83]
s_xor_b64 s[44:45], s[44:45], s[82:83]
s_xor_b64 s[46:47], s[46:47], s[82:83]
s_xor_b64 s[48:49], s[48:49], s[82:83]
s_xor_b64 s[50:51], s[50:51], s[82:83]
s_xor_b64 s[52:53], s[52:53], s[82:83]
s_xor_b64 s[54:55], s[54:55], s[82:83]
s_or_b64 s[40:41], s[40:41], s[42:43]
s_or_b64 s[44:45], s[44:45], s[46:47]
s_or_b64 s[48:49], s[48:49], s[50:51]
s_or_b64 s[52:53], s[52:53], s[54:55]
s_or_b64 s[40:41], s[40:41], s[44:45]
s_or_b64 s[48:49], s[48:49], s[52:53]
s_or_b64 s[40:41], s[40:41], s[48:49]
s_cbranch_scc1 L_sppoll
L_pgather:
buffer_load_dword v12, v14, s[64:67], s79 offen sc1
buffer_load_dwordx4 v[16:19], v5, s[64:67], s78 offen sc1
s_add_u32 s70, s78, 32768
buffer_load_dwordx4 v[20:23], v5, s[64:67], s70 offen sc1
s_add_u32 s70, s78, 65536
buffer_load_dwordx4 v[24:27], v5, s[64:67], s70 offen sc1
s_add_u32 s70, s78, 98304
buffer_load_dwordx4 v[28:31], v5, s[64:67], s70 offen sc1
s_add_u32 s70, s78, 131072
buffer_load_dwordx4 v[32:35], v5, s[64:67], s70 offen sc1
s_add_u32 s70, s78, 163840
buffer_load_dwordx4 v[36:39], v5, s[64:67], s70 offen sc1
s_add_u32 s70, s78, 196608
buffer_load_dwordx4 v[40:43], v5, s[64:67], s70 offen sc1
s_add_u32 s70, s78, 229376
buffer_load_dwordx4 v[44:47], v5, s[64:67], s70 offen sc1
s_add_u32 s81, s81, 1
s_waitcnt vmcnt(8)
v_and_b32 v48, s77, v12
v_xor_b32 v10, s74, v12
v_mov_b32 v50, v48
v_mov_b32 v11, 0
s_nop 1
v_max_f32_dpp v50, v50, v50 row_ror:1 row_mask:0xf bank_mask:0xf
s_nop 1
v_max_f32_dpp v50, v50, v50 row_ror:2 row_mask:0xf bank_mask:0xf
s_nop 1
v_max_f32_dpp v50, v50, v50 row_ror:4 row_mask:0xf bank_mask:0xf
s_nop 1
v_max_f32_dpp v50, v50, v50 row_ror:8 row_mask:0xf bank_mask:0xf
v_mov_b32 v51, v50
s_nop 1
v_permlane16_swap_b32 v50, v51
s_nop 1
v_max_f32 v50, v50, v51
v_mov_b32 v51, v50
s_nop 1
v_permlane32_swap_b32 v50, v51
s_nop 1
v_max_f32 v50, v50, v51

    v_sub_f32 v48, v48, v50
    v_exp_f32 v49, v48
    s_nop 0
    ds_write_b32 v6, v49
    s_waitcnt lgkmcnt(0)
    ds_read_b128 v[52:55], v7
    ds_read_b128 v[56:59], v7 offset:16
s_nop 1
v_add_f32_dpp v49, v49, v49 row_ror:1 row_mask:0xf bank_mask:0xf
s_nop 1
v_add_f32_dpp v49, v49, v49 row_ror:2 row_mask:0xf bank_mask:0xf
s_nop 1
v_add_f32_dpp v49, v49, v49 row_ror:4 row_mask:0xf bank_mask:0xf
s_nop 1
v_add_f32_dpp v49, v49, v49 row_ror:8 row_mask:0xf bank_mask:0xf
v_mov_b32 v51, v49
s_nop 1
v_permlane16_swap_b32 v49, v51
s_nop 1
v_add_f32 v49, v49, v51
v_mov_b32 v51, v49
s_nop 1
v_permlane32_swap_b32 v49, v51
s_nop 1
v_add_f32 v49, v49, v51
v_rcp_f32 v68, v49
s_waitcnt lgkmcnt(0)
s_waitcnt vmcnt(7)
v_bitop3_b32 v10, v10, v16, s74 bitop3:0xf6
v_bitop3_b32 v11, v11, v17, s74 bitop3:0xf6
v_bitop3_b32 v10, v10, v18, s74 bitop3:0xf6
v_bitop3_b32 v11, v11, v19, s74 bitop3:0xf6
v_and_b32 v16, s77, v16
v_and_b32 v17, s77, v17
v_and_b32 v18, s77, v18
v_and_b32 v19, s77, v19
v_pk_mul_f32 v[60:61], v[16:17], v[52:53] op_sel_hi:[1,0]
v_pk_mul_f32 v[62:63], v[18:19], v[52:53] op_sel_hi:[1,0]
s_waitcnt vmcnt(6)
v_bitop3_b32 v10, v10, v20, s74 bitop3:0xf6
v_bitop3_b32 v11, v11, v21, s74 bitop3:0xf6
v_bitop3_b32 v10, v10, v22, s74 bitop3:0xf6
v_bitop3_b32 v11, v11, v23, s74 bitop3:0xf6
v_and_b32 v20, s77, v20
v_and_b32 v21, s77, v21
v_and_b32 v22, s77, v22
v_and_b32 v23, s77, v23
v_pk_fma_f32 v[60:61], v[20:21], v[52:53], v[60:61] op_sel:[0,1,0] op_sel_hi:[1,1,1]
v_pk_fma_f32 v[62:63], v[22:23], v[52:53], v[62:63] op_sel:[0,1,0] op_sel_hi:[1,1,1]
s_waitcnt vmcnt(5)
v_bitop3_b32 v10, v10, v24, s74 bitop3:0xf6
v_bitop3_b32 v11, v11, v25, s74 bitop3:0xf6
v_bitop3_b32 v10, v10, v26, s74 bitop3:0xf6
v_bitop3_b32 v11, v11, v27, s74 bitop3:0xf6
v_and_b32 v24, s77, v24
v_and_b32 v25, s77, v25
v_and_b32 v26, s77, v26
v_and_b32 v27, s77, v27
v_pk_fma_f32 v[60:61], v[24:25], v[54:55], v[60:61] op_sel:[0,0,0] op_sel_hi:[1,0,1]
v_pk_fma_f32 v[62:63], v[26:27], v[54:55], v[62:63] op_sel:[0,0,0] op_sel_hi:[1,0,1]
s_waitcnt vmcnt(4)
v_bitop3_b32 v10, v10, v28, s74 bitop3:0xf6
v_bitop3_b32 v11, v11, v29, s74 bitop3:0xf6
v_bitop3_b32 v10, v10, v30, s74 bitop3:0xf6
v_bitop3_b32 v11, v11, v31, s74 bitop3:0xf6
v_and_b32 v28, s77, v28
v_and_b32 v29, s77, v29
v_and_b32 v30, s77, v30
v_and_b32 v31, s77, v31
v_pk_fma_f32 v[60:61], v[28:29], v[54:55], v[60:61] op_sel:[0,1,0] op_sel_hi:[1,1,1]
v_pk_fma_f32 v[62:63], v[30:31], v[54:55], v[62:63] op_sel:[0,1,0] op_sel_hi:[1,1,1]
s_waitcnt vmcnt(3)
v_bitop3_b32 v10, v10, v32, s74 bitop3:0xf6
v_bitop3_b32 v11, v11, v33, s74 bitop3:0xf6
v_bitop3_b32 v10, v10, v34, s74 bitop3:0xf6
v_bitop3_b32 v11, v11, v35, s74 bitop3:0xf6
v_and_b32 v32, s77, v32
v_and_b32 v33, s77, v33
v_and_b32 v34, s77, v34
v_and_b32 v35, s77, v35
v_pk_fma_f32 v[60:61], v[32:33], v[56:57], v[60:61] op_sel:[0,0,0] op_sel_hi:[1,0,1]
v_pk_fma_f32 v[62:63], v[34:35], v[56:57], v[62:63] op_sel:[0,0,0] op_sel_hi:[1,0,1]
s_waitcnt vmcnt(2)
v_bitop3_b32 v10, v10, v36, s74 bitop3:0xf6
v_bitop3_b32 v11, v11, v37, s74 bitop3:0xf6
v_bitop3_b32 v10, v10, v38, s74 bitop3:0xf6
v_bitop3_b32 v11, v11, v39, s74 bitop3:0xf6
v_and_b32 v36, s77, v36
v_and_b32 v37, s77, v37
v_and_b32 v38, s77, v38
v_and_b32 v39, s77, v39
v_pk_fma_f32 v[60:61], v[36:37], v[56:57], v[60:61] op_sel:[0,1,0] op_sel_hi:[1,1,1]
v_pk_fma_f32 v[62:63], v[38:39], v[56:57], v[62:63] op_sel:[0,1,0] op_sel_hi:[1,1,1]
s_waitcnt vmcnt(1)
v_bitop3_b32 v10, v10, v40, s74 bitop3:0xf6
v_bitop3_b32 v11, v11, v41, s74 bitop3:0xf6
v_bitop3_b32 v10, v10, v42, s74 bitop3:0xf6
v_bitop3_b32 v11, v11, v43, s74 bitop3:0xf6
v_and_b32 v40, s77, v40
v_and_b32 v41, s77, v41
v_and_b32 v42, s77, v42
v_and_b32 v43, s77, v43
v_pk_fma_f32 v[60:61], v[40:41], v[58:59], v[60:61] op_sel:[0,0,0] op_sel_hi:[1,0,1]
v_pk_fma_f32 v[62:63], v[42:43], v[58:59], v[62:63] op_sel:[0,0,0] op_sel_hi:[1,0,1]
s_waitcnt vmcnt(0)
v_bitop3_b32 v10, v10, v44, s74 bitop3:0xf6
v_bitop3_b32 v11, v11, v45, s74 bitop3:0xf6
v_bitop3_b32 v10, v10, v46, s74 bitop3:0xf6
v_bitop3_b32 v11, v11, v47, s74 bitop3:0xf6
v_and_b32 v44, s77, v44
v_and_b32 v45, s77, v45
v_and_b32 v46, s77, v46
v_and_b32 v47, s77, v47
v_pk_fma_f32 v[60:61], v[44:45], v[58:59], v[60:61] op_sel:[0,1,0] op_sel_hi:[1,1,1]
v_pk_fma_f32 v[62:63], v[46:47], v[58:59], v[62:63] op_sel:[0,1,0] op_sel_hi:[1,1,1]
v_or_b32 v10, v10, v11
    v_and_b32 v10, s75, v10
    v_cmp_ne_u32 vcc, 0, v10
    s_cbranch_vccz L_pok
    s_cmp_gt_u32 s81, 400000
    s_cbranch_scc0 L_pgather
L_pok:
v_add_f32_dpp v60, v60, v60 row_ror:8 row_mask:0xf bank_mask:0xf
v_add_f32_dpp v61, v61, v61 row_ror:8 row_mask:0xf bank_mask:0xf
v_add_f32_dpp v62, v62, v62 row_ror:8 row_mask:0xf bank_mask:0xf
v_add_f32_dpp v63, v63, v63 row_ror:8 row_mask:0xf bank_mask:0xf
v_mov_b32 v64, v60
v_mov_b32 v65, v61
v_mov_b32 v66, v62
v_mov_b32 v67, v63
v_permlane16_swap_b32 v60, v64
v_permlane16_swap_b32 v61, v65
v_permlane16_swap_b32 v62, v66
v_permlane16_swap_b32 v63, v67
v_add_f32 v60, v60, v64
v_add_f32 v61, v61, v65
v_add_f32 v62, v62, v66
v_add_f32 v63, v63, v67
v_mov_b32 v64, v60
v_mov_b32 v65, v61
v_mov_b32 v66, v62
v_mov_b32 v67, v63
v_permlane32_swap_b32 v60, v64
v_permlane32_swap_b32 v61, v65
v_permlane32_swap_b32 v62, v66
v_permlane32_swap_b32 v63, v67
v_add_f32 v60, v60, v64
v_add_f32 v61, v61, v65
v_add_f32 v62, v62, v66
v_add_f32 v63, v63, v67
v_pk_mul_f32 v[60:61], v[60:61], v[68:69] op_sel_hi:[1,0]
    v_pk_mul_f32 v[62:63], v[62:63], v[68:69] op_sel_hi:[1,0]
    s_mov_b64 exec, 0xff
    v_cvt_pk_bf16_f32 v60, v60, v61
    v_cvt_pk_bf16_f32 v61, v62, v63
    ds_write_b64 v3, v[60:61]
s_waitcnt lgkmcnt(0)
s_barrier
L_fin:

L_end:
    s_endpgm
.section .rodata,"a"
.p2align 6

.amdhsa_kernel concat_heads__sliding_block_cached__gqa_block_cached__decode_kernel
  .amdhsa_next_free_vgpr 256
  .amdhsa_next_free_sgpr 102
  .amdhsa_accum_offset 176
  .amdhsa_group_segment_fixed_size 0
  .amdhsa_kernarg_size 104
  .amdhsa_user_sgpr_count 2
  .amdhsa_user_sgpr_kernarg_segment_ptr 1
  .amdhsa_system_sgpr_workgroup_id_x 1
  .amdhsa_float_denorm_mode_32 3
.end_amdhsa_kernel
```
